```python
import torch

def _softmax(x, axis=-1):
    return torch.softmax(x, dim=axis)
def _gelu(x):
    return torch.nn.functional.gelu(x, approximate="tanh")
def _silu(x):
    return torch.nn.functional.silu(x)
def _sigmoid(x):
    return torch.sigmoid(x)
def _layernorm(x, axis=-1, eps=1e-5):
    m = x.mean(dim=axis, keepdim=True)
    v = x.var(dim=axis, keepdim=True, unbiased=False)
    return (x - m) / torch.sqrt(v + eps)
def _scatter_add(tgt, idx, src, axis=0):
    return tgt.clone().index_add_(axis, idx, src)
def _segment_sum(src, seg, n):
    out = torch.zeros((n,) + src.shape[1:], dtype=src.dtype)
    return out.index_add_(0, seg, src)
def _pad(x, pw):
    flat = tuple(v for pair in reversed(pw) for v in pair)
    return torch.nn.functional.pad(x, flat)

kernel_name = 'gated_mix__sliding_local_dilated__grouped_kv_mqa__prompt'

def setup_inputs():

    _w = (lambda a: (lambda t: t.to(torch.bfloat16) if t.is_floating_point() else t)(torch.as_tensor(a)))
    def _A_setup():
        B, S, D = 1, 2048, 512
        return {
            "x": _w((lambda *s: torch.randn(*s, dtype=torch.bfloat16) * 0.05)(B, S, D)),
            "wqkv": _w((lambda *s: torch.randn(*s, dtype=torch.bfloat16) * 0.8)(D, 3 * D)),
            "wo": _w((lambda *s: torch.randn(*s, dtype=torch.bfloat16) * 0.05)(D, D)),
        }
    _A_in = _A_setup()

    def _B_setup():
        B, S, D, H = 1, 2048, 512, 32
        Dh = D // H
        return {
            "x": _w((lambda *s: torch.randn(*s, dtype=torch.bfloat16) * 0.05)(B, S, D)),
            "wq": _w((lambda *s: torch.randn(*s, dtype=torch.bfloat16) * 1.6)(D, H * Dh)),
            "wk": _w((lambda *s: torch.randn(*s, dtype=torch.bfloat16) * 1.6)(D, Dh)),
            "wv": _w((lambda *s: torch.randn(*s, dtype=torch.bfloat16) * 0.2)(D, Dh)),
            "wo": _w((lambda *s: torch.randn(*s, dtype=torch.bfloat16) * 0.2)(H * Dh, D)),
        }
    _B_in = _B_setup()

    return {
        "A_x": _A_in["x"],
        "A_wqkv": _A_in["wqkv"],
        "A_wo": _A_in["wo"],
        "B_x": _B_in["x"],
        "B_wq": _B_in["wq"],
        "B_wk": _B_in["wk"],
        "B_wv": _B_in["wv"],
        "B_wo": _B_in["wo"],
        "gate_w": _w((lambda *s: torch.randn(*s, dtype=torch.bfloat16) * 0.05)(512) * 16.0),
    }

def reference(A_x, A_wqkv, A_wo, B_x, B_wq, B_wk, B_wv, B_wo, gate_w):
    def _A_ref(x, wqkv, wo):
        B, S, D = x.shape
        H = 32; Dh = D // H
        W, dil = 8, 2
        qkv = (lambda x, *d: x.permute(*d))((x @ wqkv).reshape(B, S, 3, H, Dh), 2, 0, 3, 1, 4)
        q, k, v = qkv[0], qkv[1], qkv[2]
        scale = Dh ** -0.5
        pos = torch.arange(S)
        off = torch.arange(W) * dil
        idx = pos[:, None] - off[None, :]
        mask = idx >= 0
        idx_c = torch.where(mask, idx, 0).reshape(-1)
        kg = k[:, :, idx_c, :].reshape(B, H, S, W, Dh)
        vg = v[:, :, idx_c, :].reshape(B, H, S, W, Dh)
        logits = torch.einsum("bhsd,bhswd->bhsw", q, kg) * scale
        logits = torch.where(mask[None, None, :, :], logits, -1e9)
        attn = _softmax(logits, axis=-1)
        o = torch.einsum("bhsw,bhswd->bhsd", attn, vg)
        return (lambda x, *d: x.permute(*d))(o, 0, 2, 1, 3).reshape(B, S, D) @ wo

    def _B_ref(x, wq, wk, wv, wo):
        B, S, D = x.shape
        H = 32
        Dh = D // H
        q = (lambda x, *d: x.permute(*d))((x @ wq).reshape(B, S, H, Dh), 0, 2, 1, 3)
        k = x @ wk
        v = x @ wv
        scores = torch.einsum("bhqd,bkd->bhqk", q, k) * (Dh ** -0.5)
        p = _softmax(scores, axis=-1)
        o = torch.einsum("bhqk,bkd->bhqd", p, v)
        return (lambda x, *d: x.permute(*d))(o, 0, 2, 1, 3).reshape(B, S, H * Dh) @ wo

    x = A_x
    g = _sigmoid((x * gate_w).sum(-1, keepdims=True))
    a = _A_ref(x, A_wqkv, A_wo)
    b = _B_ref(x, B_wq, B_wk, B_wv, B_wo)
    return g * a + (1 - g) * b
```

```asm
; @launch grid=(256,1,1) block=(512,1,1) lds=163840
.amdgcn_target "amdgcn-amd-amdhsa--gfx950"
.text
.globl gated_mix__sliding_local_dilated__grouped_kv_mqa__prompt_kernel
.p2align 8
.type gated_mix__sliding_local_dilated__grouped_kv_mqa__prompt_kernel,@function
gated_mix__sliding_local_dilated__grouped_kv_mqa__prompt_kernel:
    s_cmp_ge_u32 s2, 256
    s_cbranch_scc1 gated_mix__sliding_local_dilated__grouped_kv_mqa__prompt_kernel_end
    s_load_dwordx16 s[44:59], s[0:1], 0
    s_load_dwordx8 s[60:67], s[0:1], 64
    v_and_b32 v1, 63, v0
    v_lshrrev_b32 v5, 6, v0
    v_lshrrev_b32 v2, 5, v1
    v_readfirstlane_b32 s3, v5
    v_and_b32 v3, 31, v1
    v_lshlrev_b32 v4, 4, v1
    s_and_b32 s4, s2, 7
    s_lshr_b32 s5, s2, 3
    s_lshl_b32 s68, s4, 2
    s_and_b32 s6, s5, 3
    s_add_u32 s68, s68, s6
    s_lshr_b32 s69, s5, 2
    s_lshr_b32 s72, s69, 1
    s_and_b32 s73, s69, 1
    s_and_b32 s74, s5, 7
    s_mov_b32 s76, 0x3eb8aa3b
    s_mov_b32 s78, 0x0000ffff
    s_mov_b32 s79, 0x0000ffff
    v_lshrrev_b32 v5, 4, v1
    v_and_b32 v6, 7, v1
    v_xor_b32 v7, v5, v6
    v_lshrrev_b32 v8, 3, v1
    v_lshlrev_b32 v8, 10, v8
    v_lshl_add_u32 v9, v7, 4, v8
    v_xor_b32 v10, 64, v9
    v_and_b32 v5, 1, v5
    v_lshlrev_b32 v5, 2, v5
    v_xor_b32 v5, v5, v6
    v_lshl_add_u32 v11, v5, 4, v8
    s_waitcnt lgkmcnt(0)
    s_load_dword s75, s[66:67], 131072
    s_mov_b32 s8, s44
    s_mov_b32 s9, s45
    s_mov_b32 s10, 2097152
    s_mov_b32 s11, 0x00020000
    s_cmp_eq_u32 s73, 0
    s_cselect_b32 s16, s54, s56
    s_cselect_b32 s17, s55, s57
    s_mov_b32 s18, 16384
    s_mov_b32 s19, 0x00020000
    s_lshl_b32 s4, s3, 11
    s_lshl_b32 s5, s74, 11
    s_add_u32 s5, s5, s4
    s_add_u32 m0, s4, 131072
    s_and_b32 s5, s5, 16383
    buffer_load_dwordx4 v4, s[16:19], s5 offen lds
    s_lshl_b32 s4, s3, 11
    s_lshl_b32 s5, s74, 11
    s_add_u32 s5, s5, s4
    s_add_u32 s5, s5, 1024
    s_add_u32 m0, s4, 132096
    s_and_b32 s5, s5, 16383
    buffer_load_dwordx4 v4, s[16:19], s5 offen lds
    s_lshl_b32 s80, s68, 16
    s_add_u32 s4, s3, s74
    s_and_b32 s4, s4, 7
    s_lshl_b32 s4, s4, 7
    s_lshl_b32 s5, s72, 14
    s_add_u32 s4, s4, s5
    s_add_u32 s4, s4, s80
    s_lshl_b32 s5, s3, 13
    s_lshl_b32 s6, s72, 11
    s_add_u32 m0, s5, s6
    s_add_u32 s7, s4, 8192
    buffer_load_dwordx4 v9, s[8:11], s4 offen lds
    s_add_u32 m0, m0, 1024
    s_nop 0
    buffer_load_dwordx4 v10, s[8:11], s7 offen lds
    s_mov_b32 s12, s52
    s_mov_b32 s13, s53
    s_mov_b32 s14, 524288
    s_mov_b32 s15, 0x00020000
    s_mov_b32 s24, s66
    s_mov_b32 s25, s67
    s_mov_b32 s26, 10485760
    s_mov_b32 s27, 0x00020000
    s_cmp_ge_u32 s3, 4
    s_cbranch_scc1 gated_mix__sliding_local_dilated__grouped_kv_mqa__prompt_kernel_bg
    s_lshl_b32 s81, s69, 7
    s_lshl_b32 s5, s3, 14
    s_add_u32 s81, s81, s5
    s_lshl_b32 s82, s3, 11
    s_add_u32 s4, s74, 0
    s_and_b32 s4, s4, 7
    s_lshl_b32 s4, s4, 16
    s_add_u32 s4, s4, s81
    s_add_u32 m0, s82, 65536
    s_add_u32 s5, s4, 8192
    buffer_load_dwordx4 v11, s[12:15], s4 offen lds
    s_add_u32 m0, s82, 66560
    s_nop 0
    buffer_load_dwordx4 v11, s[12:15], s5 offen lds
    s_add_u32 s4, s74, 1
    s_and_b32 s4, s4, 7
    s_lshl_b32 s4, s4, 16
    s_add_u32 s4, s4, s81
    s_add_u32 m0, s82, 73728
    s_add_u32 s5, s4, 8192
    buffer_load_dwordx4 v11, s[12:15], s4 offen lds
    s_add_u32 m0, s82, 74752
    s_nop 0
    buffer_load_dwordx4 v11, s[12:15], s5 offen lds
    v_bfe_u32 v6, v1, 2, 2
    v_lshlrev_b32 v5, 7, v6
    v_lshrrev_b32 v6, 1, v6
    v_lshl_add_u32 v5, v6, 6, v5
    v_bfe_u32 v6, v1, 4, 1
    v_lshl_add_u32 v5, v6, 5, v5
    v_and_b32 v6, 3, v1
    v_lshl_add_u32 v5, v6, 3, v5
    v_lshl_add_u32 v12, v2, 10, v5
    v_lshl_add_u32 v13, v2, 9, v5
    v_add_u32 v6, 0, v2
    v_bfe_u32 v7, v3, 1, 3
    v_xor_b32 v6, v6, v7
    v_lshlrev_b32 v6, 4, v6
    v_lshl_add_u32 v14, v3, 7, v6
    v_add_u32 v6, 2, v2
    v_bfe_u32 v7, v3, 1, 3
    v_xor_b32 v6, v6, v7
    v_lshlrev_b32 v6, 4, v6
    v_lshl_add_u32 v15, v3, 7, v6
    v_add_u32 v6, 4, v2
    v_bfe_u32 v7, v3, 1, 3
    v_xor_b32 v6, v6, v7
    v_lshlrev_b32 v6, 4, v6
    v_lshl_add_u32 v16, v3, 7, v6
    v_add_u32 v6, 6, v2
    v_bfe_u32 v7, v3, 1, 3
    v_xor_b32 v6, v6, v7
    v_lshlrev_b32 v6, 4, v6
    v_lshl_add_u32 v17, v3, 7, v6
    s_lshr_b32 s4, s3, 1
    s_lshl_b32 s4, s4, 6
    v_xor_b32 v196, s4, v12
    v_add_u32 v196, 65536, v196
    s_and_b32 s4, s3, 1
    s_lshl_b32 s4, s4, 12
    v_add_u32 v197, s4, v14
    v_add_u32 v198, s4, v15
    v_add_u32 v199, s4, v16
    v_add_u32 v200, s4, v17
    v_add_u32 v188, 131072, v4
    v_lshlrev_b32 v5, 8, v2
    v_and_b32 v6, 15, v1
    v_lshl_add_u32 v189, v6, 4, v5
    v_add_u32 v189, 132096, v189
    v_mov_b32 v108, 0
    v_mov_b32 v109, 0
    v_mov_b32 v110, 0
    v_mov_b32 v111, 0
    v_mov_b32 v112, 0
    v_mov_b32 v113, 0
    v_mov_b32 v114, 0
    v_mov_b32 v115, 0
    v_mov_b32 v116, 0
    v_mov_b32 v117, 0
    v_mov_b32 v118, 0
    v_mov_b32 v119, 0
    v_mov_b32 v120, 0
    v_mov_b32 v121, 0
    v_mov_b32 v122, 0
    v_mov_b32 v123, 0
    v_mov_b32 v96, 0
    v_mov_b32 v97, 0
    v_mov_b32 v98, 0
    v_mov_b32 v99, 0
    v_mov_b32 v124, 0
    v_mov_b32 v125, 0
    v_mov_b32 v126, 0
    v_mov_b32 v127, 0
    v_mov_b32 v128, 0
    v_mov_b32 v129, 0
    v_mov_b32 v130, 0
    v_mov_b32 v131, 0
    v_mov_b32 v132, 0
    v_mov_b32 v133, 0
    v_mov_b32 v134, 0
    v_mov_b32 v135, 0
    v_mov_b32 v136, 0
    v_mov_b32 v137, 0
    v_mov_b32 v138, 0
    v_mov_b32 v139, 0
    v_mov_b32 v104, 0
    v_mov_b32 v105, 0
    v_mov_b32 v106, 0
    v_mov_b32 v107, 0
    v_and_b32 v5, 27, v1
    v_cmp_eq_u32 vcc, 16, v5
    v_mov_b32 v6, 0x3f803f80
    v_mov_b32 v7, 0
    v_cndmask_b32 v5, v7, v6, vcc
    v_mov_b32 v156, v5
    v_mov_b32 v157, v5
    v_mov_b32 v158, v5
    v_mov_b32 v159, v5
    v_mov_b32 v160, v5
    v_mov_b32 v161, v5
    v_mov_b32 v162, v5
    v_mov_b32 v163, v5
    v_mov_b32 v164, v5
    v_mov_b32 v165, v5
    v_mov_b32 v166, v5
    v_mov_b32 v167, v5
    v_mov_b32 v168, v5
    v_mov_b32 v169, v5
    v_mov_b32 v170, v5
    v_mov_b32 v171, v5
    v_mov_b32 v172, v5
    v_mov_b32 v173, v5
    v_mov_b32 v174, v5
    v_mov_b32 v175, v5
    v_mov_b32 v176, v5
    v_mov_b32 v177, v5
    v_mov_b32 v178, v5
    v_mov_b32 v179, v5
    v_mov_b32 v180, v5
    v_mov_b32 v181, v5
    v_mov_b32 v182, v5
    v_mov_b32 v183, v5
    v_mov_b32 v184, v5
    v_mov_b32 v185, v5
    v_mov_b32 v186, v5
    v_mov_b32 v187, v5
    s_waitcnt lgkmcnt(0)
    s_add_u32 s75, s75, 0x9e3779b9
    s_waitcnt vmcnt(4)
    s_barrier
    s_add_u32 s4, s74, 2
    s_and_b32 s4, s4, 7
    s_lshl_b32 s4, s4, 16
    s_add_u32 s4, s4, s81
    s_add_u32 m0, s82, 81920
    s_add_u32 s5, s4, 8192
    buffer_load_dwordx4 v11, s[12:15], s4 offen lds
    s_add_u32 m0, s82, 82944
    s_nop 0
    buffer_load_dwordx4 v11, s[12:15], s5 offen lds
    s_add_u32 s4, s74, 3
    s_and_b32 s4, s4, 7
    s_lshl_b32 s4, s4, 16
    s_add_u32 s4, s4, s81
    s_add_u32 m0, s82, 90112
    s_add_u32 s5, s4, 8192
    buffer_load_dwordx4 v11, s[12:15], s4 offen lds
    s_add_u32 m0, s82, 91136
    s_nop 0
    buffer_load_dwordx4 v11, s[12:15], s5 offen lds
    s_barrier
    s_add_u32 s4, s74, 4
    s_and_b32 s4, s4, 7
    s_lshl_b32 s4, s4, 16
    s_add_u32 s4, s4, s81
    s_add_u32 m0, s82, 98304
    s_add_u32 s5, s4, 8192
    buffer_load_dwordx4 v11, s[12:15], s4 offen lds
    s_add_u32 m0, s82, 99328
    s_nop 0
    buffer_load_dwordx4 v11, s[12:15], s5 offen lds
    s_add_u32 s4, s74, 5
    s_and_b32 s4, s4, 7
    s_lshl_b32 s4, s4, 16
    s_add_u32 s4, s4, s81
    s_add_u32 m0, s82, 106496
    s_add_u32 s5, s4, 8192
    buffer_load_dwordx4 v11, s[12:15], s4 offen lds
    s_add_u32 m0, s82, 107520
    s_nop 0
    buffer_load_dwordx4 v11, s[12:15], s5 offen lds
    s_add_u32 s4, s74, 6
    s_and_b32 s4, s4, 7
    s_lshl_b32 s4, s4, 16
    s_add_u32 s4, s4, s81
    s_add_u32 m0, s82, 114688
    s_add_u32 s5, s4, 8192
    buffer_load_dwordx4 v11, s[12:15], s4 offen lds
    s_add_u32 m0, s82, 115712
    s_nop 0
    buffer_load_dwordx4 v11, s[12:15], s5 offen lds
    s_add_u32 s4, s74, 7
    s_and_b32 s4, s4, 7
    s_lshl_b32 s4, s4, 16
    s_add_u32 s4, s4, s81
    s_add_u32 m0, s82, 122880
    s_add_u32 s5, s4, 8192
    buffer_load_dwordx4 v11, s[12:15], s4 offen lds
    s_add_u32 m0, s82, 123904
    s_nop 0
    buffer_load_dwordx4 v11, s[12:15], s5 offen lds
    s_waitcnt vmcnt(8)
    s_barrier
    ds_read_b128 v[140:143], v197 offset:0
    ds_read_b64_tr_b16 v[76:77], v196 offset:0
    ds_read_b64_tr_b16 v[78:79], v196 offset:512
    ds_read_b128 v[144:147], v198 offset:0
    ds_read_b64_tr_b16 v[80:81], v196 offset:2048
    ds_read_b64_tr_b16 v[82:83], v196 offset:2560
    ds_read_b128 v[148:151], v199 offset:0
    ds_read_b64_tr_b16 v[84:85], v196 offset:4096
    ds_read_b64_tr_b16 v[86:87], v196 offset:4608
    ds_read_b128 v[152:155], v200 offset:0
    ds_read_b64_tr_b16 v[88:89], v196 offset:6144
    ds_read_b64_tr_b16 v[90:91], v196 offset:6656
    s_waitcnt lgkmcnt(9)
    v_mfma_f32_32x32x16_bf16 v[60:75], v[76:79], v[140:143], 0
    ds_read_b128 v[28:31], v197 offset:8192
    ds_read_b64_tr_b16 v[32:33], v196 offset:8192
    ds_read_b64_tr_b16 v[34:35], v196 offset:8704
    s_waitcnt lgkmcnt(9)
    v_mfma_f32_32x32x16_bf16 v[60:75], v[80:83], v[144:147], v[60:75]
    ds_read_b128 v[140:143], v198 offset:8192
    ds_read_b64_tr_b16 v[76:77], v196 offset:10240
    ds_read_b64_tr_b16 v[78:79], v196 offset:10752
    s_waitcnt lgkmcnt(9)
    v_mfma_f32_32x32x16_bf16 v[60:75], v[84:87], v[148:151], v[60:75]
    ds_read_b128 v[144:147], v199 offset:8192
    ds_read_b64_tr_b16 v[80:81], v196 offset:12288
    ds_read_b64_tr_b16 v[82:83], v196 offset:12800
    s_waitcnt lgkmcnt(9)
    v_mfma_f32_32x32x16_bf16 v[60:75], v[88:91], v[152:155], v[60:75]
    ds_read_b128 v[148:151], v200 offset:8192
    ds_read_b64_tr_b16 v[84:85], v196 offset:14336
    ds_read_b64_tr_b16 v[86:87], v196 offset:14848
    s_waitcnt lgkmcnt(9)
    v_mfma_f32_32x32x16_bf16 v[60:75], v[32:35], v[28:31], v[60:75]
    ds_read_b128 v[152:155], v197 offset:16384
    ds_read_b64_tr_b16 v[88:89], v196 offset:16384
    ds_read_b64_tr_b16 v[90:91], v196 offset:16896
    s_waitcnt lgkmcnt(9)
    v_mfma_f32_32x32x16_bf16 v[60:75], v[76:79], v[140:143], v[60:75]
    ds_read_b128 v[28:31], v198 offset:16384
    ds_read_b64_tr_b16 v[32:33], v196 offset:18432
    ds_read_b64_tr_b16 v[34:35], v196 offset:18944
    s_waitcnt lgkmcnt(9)
    v_mfma_f32_32x32x16_bf16 v[60:75], v[80:83], v[144:147], v[60:75]
    ds_read_b128 v[140:143], v199 offset:16384
    ds_read_b64_tr_b16 v[76:77], v196 offset:20480
    ds_read_b64_tr_b16 v[78:79], v196 offset:20992
    s_waitcnt lgkmcnt(9)
    v_mfma_f32_32x32x16_bf16 v[60:75], v[84:87], v[148:151], v[60:75]
    ds_read_b128 v[144:147], v200 offset:16384
    ds_read_b64_tr_b16 v[80:81], v196 offset:22528
    ds_read_b64_tr_b16 v[82:83], v196 offset:23040
    s_waitcnt lgkmcnt(9)
    v_mfma_f32_32x32x16_bf16 v[60:75], v[88:91], v[152:155], v[60:75]
    ds_read_b128 v[148:151], v197 offset:24576
    ds_read_b64_tr_b16 v[84:85], v196 offset:24576
    ds_read_b64_tr_b16 v[86:87], v196 offset:25088
    s_waitcnt lgkmcnt(9)
    v_mfma_f32_32x32x16_bf16 v[60:75], v[32:35], v[28:31], v[60:75]
    ds_read_b128 v[152:155], v198 offset:24576
    ds_read_b64_tr_b16 v[88:89], v196 offset:26624
    ds_read_b64_tr_b16 v[90:91], v196 offset:27136
    s_waitcnt lgkmcnt(9)
    v_mfma_f32_32x32x16_bf16 v[60:75], v[76:79], v[140:143], v[60:75]
    ds_read_b128 v[28:31], v199 offset:24576
    ds_read_b64_tr_b16 v[32:33], v196 offset:28672
    ds_read_b64_tr_b16 v[34:35], v196 offset:29184
    s_waitcnt lgkmcnt(9)
    v_mfma_f32_32x32x16_bf16 v[60:75], v[80:83], v[144:147], v[60:75]
    ds_read_b128 v[140:143], v200 offset:24576
    ds_read_b64_tr_b16 v[76:77], v196 offset:30720
    ds_read_b64_tr_b16 v[78:79], v196 offset:31232
    s_waitcnt lgkmcnt(9)
    v_mfma_f32_32x32x16_bf16 v[60:75], v[84:87], v[148:151], v[60:75]
    s_waitcnt lgkmcnt(6)
    v_mfma_f32_32x32x16_bf16 v[60:75], v[88:91], v[152:155], v[60:75]
    s_waitcnt lgkmcnt(3)
    v_mfma_f32_32x32x16_bf16 v[60:75], v[32:35], v[28:31], v[60:75]
    s_waitcnt lgkmcnt(0)
    v_mfma_f32_32x32x16_bf16 v[60:75], v[76:79], v[140:143], v[60:75]
    s_waitcnt vmcnt(0)
    s_barrier
    v_lshlrev_b32 v190, 5, v1
    s_lshl_b32 s4, s2, 2
    s_add_u32 s4, s4, s3
    s_and_b32 s4, s4, 63
    s_lshl_b32 s4, s4, 11
    s_add_u32 s4, s4, 262144
    buffer_load_dwordx4 v[44:47], v190, s[24:27], s4 offen sc1
    buffer_load_dwordx4 v[48:51], v190, s[24:27], s4 offen offset:16 sc1
gated_mix__sliding_local_dilated__grouped_kv_mqa__prompt_kernel_nofl:
    ds_read_b128 v[144:147], v197 offset:32768
    ds_read_b64_tr_b16 v[80:81], v196 offset:32768
    ds_read_b64_tr_b16 v[82:83], v196 offset:33280
    ds_read_b128 v[148:151], v198 offset:32768
    ds_read_b64_tr_b16 v[84:85], v196 offset:34816
    ds_read_b64_tr_b16 v[86:87], v196 offset:35328
    ds_read_b128 v[152:155], v199 offset:32768
    ds_read_b64_tr_b16 v[88:89], v196 offset:36864
    ds_read_b64_tr_b16 v[90:91], v196 offset:37376
    ds_read_b128 v[28:31], v200 offset:32768
    ds_read_b64_tr_b16 v[32:33], v196 offset:38912
    ds_read_b64_tr_b16 v[34:35], v196 offset:39424
    s_waitcnt lgkmcnt(9)
    v_mfma_f32_32x32x16_bf16 v[60:75], v[80:83], v[144:147], v[60:75]
    ds_read_b128 v[140:143], v197 offset:40960
    ds_read_b64_tr_b16 v[76:77], v196 offset:40960
    ds_read_b64_tr_b16 v[78:79], v196 offset:41472
    s_waitcnt lgkmcnt(9)
    v_mfma_f32_32x32x16_bf16 v[60:75], v[84:87], v[148:151], v[60:75]
    ds_read_b128 v[144:147], v198 offset:40960
    ds_read_b64_tr_b16 v[80:81], v196 offset:43008
    ds_read_b64_tr_b16 v[82:83], v196 offset:43520
    s_waitcnt lgkmcnt(9)
    v_mfma_f32_32x32x16_bf16 v[60:75], v[88:91], v[152:155], v[60:75]
    ds_read_b128 v[148:151], v199 offset:40960
    ds_read_b64_tr_b16 v[84:85], v196 offset:45056
    ds_read_b64_tr_b16 v[86:87], v196 offset:45568
    s_waitcnt lgkmcnt(9)
    v_mfma_f32_32x32x16_bf16 v[60:75], v[32:35], v[28:31], v[60:75]
    ds_read_b128 v[152:155], v200 offset:40960
    ds_read_b64_tr_b16 v[88:89], v196 offset:47104
    ds_read_b64_tr_b16 v[90:91], v196 offset:47616
    s_waitcnt lgkmcnt(9)
    v_mfma_f32_32x32x16_bf16 v[60:75], v[76:79], v[140:143], v[60:75]
    ds_read_b128 v[28:31], v197 offset:49152
    ds_read_b64_tr_b16 v[32:33], v196 offset:49152
    ds_read_b64_tr_b16 v[34:35], v196 offset:49664
    s_waitcnt lgkmcnt(9)
    v_mfma_f32_32x32x16_bf16 v[60:75], v[80:83], v[144:147], v[60:75]
    ds_read_b128 v[140:143], v198 offset:49152
    ds_read_b64_tr_b16 v[76:77], v196 offset:51200
    ds_read_b64_tr_b16 v[78:79], v196 offset:51712
    s_waitcnt lgkmcnt(9)
    v_mfma_f32_32x32x16_bf16 v[60:75], v[84:87], v[148:151], v[60:75]
    ds_read_b128 v[144:147], v199 offset:49152
    ds_read_b64_tr_b16 v[80:81], v196 offset:53248
    ds_read_b64_tr_b16 v[82:83], v196 offset:53760
    s_waitcnt lgkmcnt(9)
    v_mfma_f32_32x32x16_bf16 v[60:75], v[88:91], v[152:155], v[60:75]
    ds_read_b128 v[148:151], v200 offset:49152
    ds_read_b64_tr_b16 v[84:85], v196 offset:55296
    ds_read_b64_tr_b16 v[86:87], v196 offset:55808
    s_waitcnt lgkmcnt(9)
    v_mfma_f32_32x32x16_bf16 v[60:75], v[32:35], v[28:31], v[60:75]
    ds_read_b128 v[152:155], v197 offset:57344
    ds_read_b64_tr_b16 v[88:89], v196 offset:57344
    ds_read_b64_tr_b16 v[90:91], v196 offset:57856
    s_waitcnt lgkmcnt(9)
    v_mfma_f32_32x32x16_bf16 v[60:75], v[76:79], v[140:143], v[60:75]
    ds_read_b128 v[28:31], v198 offset:57344
    ds_read_b64_tr_b16 v[32:33], v196 offset:59392
    ds_read_b64_tr_b16 v[34:35], v196 offset:59904
    s_waitcnt lgkmcnt(9)
    v_mfma_f32_32x32x16_bf16 v[60:75], v[80:83], v[144:147], v[60:75]
    ds_read_b128 v[140:143], v199 offset:57344
    ds_read_b64_tr_b16 v[76:77], v196 offset:61440
    ds_read_b64_tr_b16 v[78:79], v196 offset:61952
    s_waitcnt lgkmcnt(9)
    v_mfma_f32_32x32x16_bf16 v[60:75], v[84:87], v[148:151], v[60:75]
    ds_read_b128 v[144:147], v200 offset:57344
    ds_read_b64_tr_b16 v[80:81], v196 offset:63488
    ds_read_b64_tr_b16 v[82:83], v196 offset:64000
    s_waitcnt lgkmcnt(9)
    v_mfma_f32_32x32x16_bf16 v[60:75], v[88:91], v[152:155], v[60:75]
    s_waitcnt lgkmcnt(6)
    v_mfma_f32_32x32x16_bf16 v[60:75], v[32:35], v[28:31], v[60:75]
    s_waitcnt lgkmcnt(3)
    v_mfma_f32_32x32x16_bf16 v[60:75], v[76:79], v[140:143], v[60:75]
    s_waitcnt lgkmcnt(0)
    v_mfma_f32_32x32x16_bf16 v[60:75], v[80:83], v[144:147], v[60:75]
    s_barrier
    s_mov_b32 s77, 0
    s_branch gated_mix__sliding_local_dilated__grouped_kv_mqa__prompt_kernel_apoll1_chk
gated_mix__sliding_local_dilated__grouped_kv_mqa__prompt_kernel_apoll1:
    s_lshl_b32 s4, s2, 2
    s_add_u32 s4, s4, s3
    s_and_b32 s4, s4, 63
    s_lshl_b32 s4, s4, 11
    s_add_u32 s4, s4, 262144
    buffer_load_dwordx4 v[44:47], v190, s[24:27], s4 offen sc1
    buffer_load_dwordx4 v[48:51], v190, s[24:27], s4 offen offset:16 sc1
gated_mix__sliding_local_dilated__grouped_kv_mqa__prompt_kernel_apoll1_chk:
    s_waitcnt vmcnt(0)
    v_xor_b32 v6, s75, v44
    v_xor_b32 v7, s75, v46
    v_or_b32 v6, v6, v7
    v_xor_b32 v7, s75, v48
    v_xor_b32 v8, s75, v50
    v_or3_b32 v6, v6, v7, v8
    v_cmp_ne_u32 vcc, 0, v6
    s_add_u32 s77, s77, 1
    s_cmp_ge_u32 s77, 200000
    s_cbranch_scc1 gated_mix__sliding_local_dilated__grouped_kv_mqa__prompt_kernel_apoll1_done
    s_cbranch_vccz gated_mix__sliding_local_dilated__grouped_kv_mqa__prompt_kernel_apoll1_done
    s_sleep 4
    s_branch gated_mix__sliding_local_dilated__grouped_kv_mqa__prompt_kernel_apoll1
gated_mix__sliding_local_dilated__grouped_kv_mqa__prompt_kernel_apoll1_done:
    s_lshl_b32 s6, s3, 10
    s_add_u32 m0, s6, 131072
    s_add_u32 s5, s6, 0
    buffer_load_dwordx4 v4, s[24:27], s5 offen lds
    s_add_u32 m0, s6, 135168
    s_add_u32 s5, s6, 4096
    buffer_load_dwordx4 v4, s[24:27], s5 offen lds
    s_add_u32 m0, s6, 139264
    s_add_u32 s5, s6, 8192
    buffer_load_dwordx4 v4, s[24:27], s5 offen lds
    s_add_u32 m0, s6, 143360
    s_add_u32 s5, s6, 12288
    buffer_load_dwordx4 v4, s[24:27], s5 offen lds
    s_add_u32 m0, s6, 147456
    s_add_u32 s5, s6, 16384
    buffer_load_dwordx4 v4, s[24:27], s5 offen lds
    s_add_u32 m0, s6, 151552
    s_add_u32 s5, s6, 20480
    buffer_load_dwordx4 v4, s[24:27], s5 offen lds
    v_mov_b32 v6, 0x7f800000
    v_cmp_u_f32 vcc, v45, v45
    s_nop 1
    v_cndmask_b32 v45, v45, v6, vcc
    v_cmp_u_f32 vcc, v47, v47
    s_nop 1
    v_cndmask_b32 v47, v47, v6, vcc
    v_cmp_u_f32 vcc, v49, v49
    s_nop 1
    v_cndmask_b32 v49, v49, v6, vcc
    v_cmp_u_f32 vcc, v51, v51
    s_nop 1
    v_cndmask_b32 v51, v51, v6, vcc
    v_max_f32 v194, v45, v49
    v_max_f32 v195, v47, v51
    v_mov_b32 v6, v194
    v_mov_b32 v7, v195
    s_nop 0
    v_permlane16_swap_b32 v194, v6
    v_permlane16_swap_b32 v195, v7
    s_nop 0
    v_max_f32 v194, v194, v6
    v_max_f32 v195, v195, v7
    v_mov_b32 v6, v194
    v_mov_b32 v7, v195
    s_nop 0
    v_permlane32_swap_b32 v194, v6
    v_permlane32_swap_b32 v195, v7
    s_nop 0
    v_max_f32 v194, v194, v6
    v_max_f32 v195, v195, v7
    s_nop 0
    v_max_f32_dpp v194, v194, v194 row_ror:8 row_mask:0xf bank_mask:0xf
    v_max_f32_dpp v195, v195, v195 row_ror:8 row_mask:0xf bank_mask:0xf
    s_nop 0
    v_max_f32_dpp v194, v194, v194 row_ror:4 row_mask:0xf bank_mask:0xf
    v_max_f32_dpp v195, v195, v195 row_ror:4 row_mask:0xf bank_mask:0xf
    s_nop 0
    v_max_f32_dpp v194, v194, v194 row_ror:2 row_mask:0xf bank_mask:0xf
    v_max_f32_dpp v195, v195, v195 row_ror:2 row_mask:0xf bank_mask:0xf
    s_nop 0
    v_max_f32_dpp v194, v194, v194 row_ror:1 row_mask:0xf bank_mask:0xf
    v_max_f32_dpp v195, v195, v195 row_ror:1 row_mask:0xf bank_mask:0xf
    v_mul_f32 v60, s76, v60
    v_mul_f32 v61, s76, v61
    v_mul_f32 v62, s76, v62
    v_mul_f32 v63, s76, v63
    v_mul_f32 v64, s76, v64
    v_mul_f32 v65, s76, v65
    v_mul_f32 v66, s76, v66
    v_mul_f32 v67, s76, v67
    v_mul_f32 v68, s76, v68
    v_mul_f32 v69, s76, v69
    v_mul_f32 v70, s76, v70
    v_mul_f32 v71, s76, v71
    v_mul_f32 v72, s76, v72
    v_mul_f32 v73, s76, v73
    v_mul_f32 v74, s76, v74
    v_mul_f32 v75, s76, v75
    v_cvt_pk_bf16_f32 v20, v60, v61
    v_cvt_pk_bf16_f32 v21, v62, v63
    v_cvt_pk_bf16_f32 v22, v64, v65
    v_cvt_pk_bf16_f32 v23, v66, v67
    v_cvt_pk_bf16_f32 v24, v68, v69
    v_cvt_pk_bf16_f32 v25, v70, v71
    v_cvt_pk_bf16_f32 v26, v72, v73
    v_cvt_pk_bf16_f32 v27, v74, v75
    v_mov_b32 v192, 0
    v_mov_b32 v193, 0
    v_dot2_f32_bf16 v192, v20, v20, v192
    v_dot2_f32_bf16 v193, v24, v24, v193
    s_nop 2
    v_dot2_f32_bf16 v192, v21, v21, v192
    v_dot2_f32_bf16 v193, v25, v25, v193
    s_nop 2
    v_dot2_f32_bf16 v192, v22, v22, v192
    v_dot2_f32_bf16 v193, v26, v26, v193
    s_nop 2
    v_dot2_f32_bf16 v192, v23, v23, v192
    v_dot2_f32_bf16 v193, v27, v27, v193
    s_nop 2
    v_mov_b32 v7, v192
    s_nop 1
    v_permlane32_swap_b32 v192, v7
    s_nop 1
    v_add_f32 v192, v192, v7
    v_mov_b32 v7, v193
    s_nop 1
    v_permlane32_swap_b32 v193, v7
    s_nop 1
    v_add_f32 v193, v193, v7
    s_waitcnt vmcnt(2)
    s_barrier
    ds_read_b128 v[140:143], v188 offset:0
    ds_read_b128 v[144:147], v188 offset:2048
    ds_read_b128 v[148:151], v188 offset:4096
    s_mov_b64 exec, s[78:79]
    ds_read_b128 v[156:159], v189 offset:0
    ds_read_b128 v[160:163], v189 offset:512
    ds_read_b128 v[164:167], v189 offset:2048
    ds_read_b128 v[168:171], v189 offset:2560
    s_mov_b64 exec, -1
    s_waitcnt lgkmcnt(6)
    v_mfma_f32_32x32x16_bf16 v[60:75], v[140:143], v[20:23], 0
    v_mfma_f32_32x32x16_bf16 v[76:91], v[140:143], v[24:27], 0
    s_nop 10
    v_max3_f32 v190, v60, v61, v62
    v_max3_f32 v190, v190, v63, v64
    v_max3_f32 v190, v190, v65, v66
    v_max3_f32 v190, v190, v67, v68
    v_max3_f32 v190, v190, v69, v70
    v_max3_f32 v190, v190, v71, v72
    v_max3_f32 v190, v190, v73, v74
    v_max_f32 v190, v190, v75
    v_mov_b32 v5, v190
    s_nop 1
    v_permlane32_swap_b32 v190, v5
    s_nop 1
    v_max_f32 v190, v190, v5
    v_sub_f32 v28, 0, v190
    v_sub_f32 v29, 0, v190
    v_sub_f32 v30, 0, v190
    v_sub_f32 v31, 0, v190
    v_sub_f32 v32, 0, v190
    v_sub_f32 v33, 0, v190
    v_sub_f32 v34, 0, v190
    v_sub_f32 v35, 0, v190
    v_sub_f32 v36, 0, v190
    v_sub_f32 v37, 0, v190
    v_sub_f32 v38, 0, v190
    v_sub_f32 v39, 0, v190
    v_sub_f32 v40, 0, v190
    v_sub_f32 v41, 0, v190
    v_sub_f32 v42, 0, v190
    v_sub_f32 v43, 0, v190
    s_nop 1
    v_mfma_f32_32x32x16_bf16 v[60:75], v[140:143], v[20:23], v[28:43]
    v_max3_f32 v191, v76, v77, v78
    v_max3_f32 v191, v191, v79, v80
    v_max3_f32 v191, v191, v81, v82
    v_max3_f32 v191, v191, v83, v84
    v_max3_f32 v191, v191, v85, v86
    v_max3_f32 v191, v191, v87, v88
    v_max3_f32 v191, v191, v89, v90
    v_max_f32 v191, v191, v91
    v_mov_b32 v5, v191
    s_nop 1
    v_permlane32_swap_b32 v191, v5
    s_nop 1
    v_max_f32 v191, v191, v5
    v_sub_f32 v44, 0, v191
    v_sub_f32 v45, 0, v191
    v_sub_f32 v46, 0, v191
    v_sub_f32 v47, 0, v191
    v_sub_f32 v48, 0, v191
    v_sub_f32 v49, 0, v191
    v_sub_f32 v50, 0, v191
    v_sub_f32 v51, 0, v191
    v_sub_f32 v52, 0, v191
    v_sub_f32 v53, 0, v191
    v_sub_f32 v54, 0, v191
    v_sub_f32 v55, 0, v191
    v_sub_f32 v56, 0, v191
    v_sub_f32 v57, 0, v191
    v_sub_f32 v58, 0, v191
    v_sub_f32 v59, 0, v191
    s_nop 1
    v_mfma_f32_32x32x16_bf16 v[76:91], v[140:143], v[24:27], v[44:59]
    s_waitcnt lgkmcnt(0)
    s_waitcnt vmcnt(0)
    v_mov_b32 v6, 0x53800000
    v_cmp_le_f32 s[80:81], v195, v6
    v_mul_f32 v8, 0x3f83d70a, v194
    v_add_f32 v5, 0x42800000, v190
    v_mul_f32 v6, v5, v5
    v_mul_f32 v7, v8, v192
    v_cmp_le_f32 s[82:83], 0, v5
    v_cmp_le_f32 s[84:85], v7, v6
    s_nop 3
    s_and_b64 s[80:81], s[80:81], s[82:83]
    s_and_b64 s[80:81], s[80:81], s[84:85]
    v_add_f32 v5, 0x42800000, v191
    v_mul_f32 v6, v5, v5
    v_mul_f32 v7, v8, v193
    v_cmp_le_f32 s[82:83], 0, v5
    v_cmp_le_f32 s[84:85], v7, v6
    s_nop 3
    s_and_b64 s[80:81], s[80:81], s[82:83]
    s_and_b64 s[80:81], s[80:81], s[84:85]
    s_mov_b32 s77, 0
    s_cmp_eq_u64 s[80:81], -1
    s_cbranch_scc0 gated_mix__sliding_local_dilated__grouped_kv_mqa__prompt_kernel_slow
.p2align 6
gated_mix__sliding_local_dilated__grouped_kv_mqa__prompt_kernel_loop:
    v_exp_f32 v60, v60
    v_exp_f32 v61, v61
    v_exp_f32 v62, v62
    v_exp_f32 v63, v63
    v_exp_f32 v64, v64
    v_exp_f32 v65, v65
    v_mfma_f32_32x32x16_bf16 v[124:139], v[184:187], v[104:107], v[124:139]
    s_mov_b64 exec, s[78:79]
    ds_read_b128 v[172:175], v189 offset:4096
    ds_read_b128 v[176:179], v189 offset:4608
    ds_read_b128 v[180:183], v189 offset:6144
    ds_read_b128 v[184:187], v189 offset:6656
    s_mov_b64 exec, -1
    v_exp_f32 v66, v66
    v_exp_f32 v67, v67
    v_cvt_pk_bf16_f32 v92, v60, v61
    v_cvt_pk_bf16_f32 v93, v62, v63
    v_cvt_pk_bf16_f32 v94, v64, v65
    v_cvt_pk_bf16_f32 v95, v66, v67
    v_exp_f32 v68, v68
    v_exp_f32 v69, v69
    v_mfma_f32_32x32x16_bf16 v[108:123], v[156:159], v[92:95], v[108:123]
    v_exp_f32 v70, v70
    v_exp_f32 v71, v71
    v_exp_f32 v72, v72
    v_exp_f32 v73, v73
    v_exp_f32 v74, v74
    v_exp_f32 v75, v75
    v_cvt_pk_bf16_f32 v96, v68, v69
    v_cvt_pk_bf16_f32 v97, v70, v71
    v_cvt_pk_bf16_f32 v98, v72, v73
    v_cvt_pk_bf16_f32 v99, v74, v75
    v_mfma_f32_32x32x16_bf16 v[60:75], v[144:147], v[20:23], v[28:43]
    v_exp_f32 v76, v76
    v_exp_f32 v77, v77
    v_exp_f32 v78, v78
    v_exp_f32 v79, v79
    v_exp_f32 v80, v80
    v_exp_f32 v81, v81
    v_mfma_f32_32x32x16_bf16 v[108:123], v[160:163], v[96:99], v[108:123]
    v_exp_f32 v82, v82
    v_exp_f32 v83, v83
    v_cvt_pk_bf16_f32 v100, v76, v77
    v_cvt_pk_bf16_f32 v101, v78, v79
    v_cvt_pk_bf16_f32 v102, v80, v81
    v_cvt_pk_bf16_f32 v103, v82, v83
    v_exp_f32 v84, v84
    v_exp_f32 v85, v85
    v_mfma_f32_32x32x16_bf16 v[124:139], v[156:159], v[100:103], v[124:139]
    v_exp_f32 v86, v86
    v_exp_f32 v87, v87
    v_exp_f32 v88, v88
    v_exp_f32 v89, v89
    v_exp_f32 v90, v90
    v_exp_f32 v91, v91
    v_cvt_pk_bf16_f32 v104, v84, v85
    v_cvt_pk_bf16_f32 v105, v86, v87
    v_cvt_pk_bf16_f32 v106, v88, v89
    v_cvt_pk_bf16_f32 v107, v90, v91
    v_mfma_f32_32x32x16_bf16 v[76:91], v[144:147], v[24:27], v[44:59]
    ds_read_b128 v[152:155], v188 offset:6144
    ds_read_b128 v[140:143], v188 offset:8192
    v_exp_f32 v60, v60
    v_exp_f32 v61, v61
    v_exp_f32 v62, v62
    v_exp_f32 v63, v63
    v_exp_f32 v64, v64
    v_exp_f32 v65, v65
    v_mfma_f32_32x32x16_bf16 v[124:139], v[160:163], v[104:107], v[124:139]
    v_exp_f32 v66, v66
    v_exp_f32 v67, v67
    v_cvt_pk_bf16_f32 v92, v60, v61
    v_cvt_pk_bf16_f32 v93, v62, v63
    v_cvt_pk_bf16_f32 v94, v64, v65
    v_cvt_pk_bf16_f32 v95, v66, v67
    v_exp_f32 v68, v68
    v_exp_f32 v69, v69
    v_mfma_f32_32x32x16_bf16 v[108:123], v[164:167], v[92:95], v[108:123]
    v_exp_f32 v70, v70
    v_exp_f32 v71, v71
    v_exp_f32 v72, v72
    v_exp_f32 v73, v73
    v_exp_f32 v74, v74
    v_exp_f32 v75, v75
    v_cvt_pk_bf16_f32 v96, v68, v69
    v_cvt_pk_bf16_f32 v97, v70, v71
    v_cvt_pk_bf16_f32 v98, v72, v73
    v_cvt_pk_bf16_f32 v99, v74, v75
    v_mfma_f32_32x32x16_bf16 v[60:75], v[148:151], v[20:23], v[28:43]
    v_exp_f32 v76, v76
    v_exp_f32 v77, v77
    v_exp_f32 v78, v78
    v_exp_f32 v79, v79
    v_exp_f32 v80, v80
    v_exp_f32 v81, v81
    v_mfma_f32_32x32x16_bf16 v[108:123], v[168:171], v[96:99], v[108:123]
    v_exp_f32 v82, v82
    v_exp_f32 v83, v83
    v_cvt_pk_bf16_f32 v100, v76, v77
    v_cvt_pk_bf16_f32 v101, v78, v79
    v_cvt_pk_bf16_f32 v102, v80, v81
    v_cvt_pk_bf16_f32 v103, v82, v83
    v_exp_f32 v84, v84
    v_exp_f32 v85, v85
    v_mfma_f32_32x32x16_bf16 v[124:139], v[164:167], v[100:103], v[124:139]
    v_exp_f32 v86, v86
    v_exp_f32 v87, v87
    v_exp_f32 v88, v88
    v_exp_f32 v89, v89
    v_exp_f32 v90, v90
    v_exp_f32 v91, v91
    v_cvt_pk_bf16_f32 v104, v84, v85
    v_cvt_pk_bf16_f32 v105, v86, v87
    v_cvt_pk_bf16_f32 v106, v88, v89
    v_cvt_pk_bf16_f32 v107, v90, v91
    v_mfma_f32_32x32x16_bf16 v[76:91], v[148:151], v[24:27], v[44:59]
    s_waitcnt lgkmcnt(0)
    v_exp_f32 v60, v60
    v_exp_f32 v61, v61
    v_exp_f32 v62, v62
    v_exp_f32 v63, v63
    v_exp_f32 v64, v64
    v_exp_f32 v65, v65
    v_mfma_f32_32x32x16_bf16 v[124:139], v[168:171], v[104:107], v[124:139]
    s_mov_b64 exec, s[78:79]
    ds_read_b128 v[156:159], v189 offset:8192
    ds_read_b128 v[160:163], v189 offset:8704
    ds_read_b128 v[164:167], v189 offset:10240
    ds_read_b128 v[168:171], v189 offset:10752
    s_mov_b64 exec, -1
    v_exp_f32 v66, v66
    v_exp_f32 v67, v67
    v_cvt_pk_bf16_f32 v92, v60, v61
    v_cvt_pk_bf16_f32 v93, v62, v63
    v_cvt_pk_bf16_f32 v94, v64, v65
    v_cvt_pk_bf16_f32 v95, v66, v67
    v_exp_f32 v68, v68
    v_exp_f32 v69, v69
    v_mfma_f32_32x32x16_bf16 v[108:123], v[172:175], v[92:95], v[108:123]
    v_exp_f32 v70, v70
    v_exp_f32 v71, v71
    v_exp_f32 v72, v72
    v_exp_f32 v73, v73
    v_exp_f32 v74, v74
    v_exp_f32 v75, v75
    v_cvt_pk_bf16_f32 v96, v68, v69
    v_cvt_pk_bf16_f32 v97, v70, v71
    v_cvt_pk_bf16_f32 v98, v72, v73
    v_cvt_pk_bf16_f32 v99, v74, v75
    v_mfma_f32_32x32x16_bf16 v[60:75], v[152:155], v[20:23], v[28:43]
    v_exp_f32 v76, v76
    v_exp_f32 v77, v77
    v_exp_f32 v78, v78
    v_exp_f32 v79, v79
    v_exp_f32 v80, v80
    v_exp_f32 v81, v81
    v_mfma_f32_32x32x16_bf16 v[108:123], v[176:179], v[96:99], v[108:123]
    v_exp_f32 v82, v82
    v_exp_f32 v83, v83
    v_cvt_pk_bf16_f32 v100, v76, v77
    v_cvt_pk_bf16_f32 v101, v78, v79
    v_cvt_pk_bf16_f32 v102, v80, v81
    v_cvt_pk_bf16_f32 v103, v82, v83
    v_exp_f32 v84, v84
    v_exp_f32 v85, v85
    v_mfma_f32_32x32x16_bf16 v[124:139], v[172:175], v[100:103], v[124:139]
    v_exp_f32 v86, v86
    v_exp_f32 v87, v87
    v_exp_f32 v88, v88
    v_exp_f32 v89, v89
    v_exp_f32 v90, v90
    v_exp_f32 v91, v91
    v_cvt_pk_bf16_f32 v104, v84, v85
    v_cvt_pk_bf16_f32 v105, v86, v87
    v_cvt_pk_bf16_f32 v106, v88, v89
    v_cvt_pk_bf16_f32 v107, v90, v91
    v_mfma_f32_32x32x16_bf16 v[76:91], v[152:155], v[24:27], v[44:59]
    ds_read_b128 v[144:147], v188 offset:10240
    ds_read_b128 v[148:151], v188 offset:12288
    v_exp_f32 v60, v60
    v_exp_f32 v61, v61
    v_exp_f32 v62, v62
    v_exp_f32 v63, v63
    v_exp_f32 v64, v64
    v_exp_f32 v65, v65
    v_mfma_f32_32x32x16_bf16 v[124:139], v[176:179], v[104:107], v[124:139]
    v_exp_f32 v66, v66
    v_exp_f32 v67, v67
    v_cvt_pk_bf16_f32 v92, v60, v61
    v_cvt_pk_bf16_f32 v93, v62, v63
    v_cvt_pk_bf16_f32 v94, v64, v65
    v_cvt_pk_bf16_f32 v95, v66, v67
    v_exp_f32 v68, v68
    v_exp_f32 v69, v69
    v_mfma_f32_32x32x16_bf16 v[108:123], v[180:183], v[92:95], v[108:123]
    v_exp_f32 v70, v70
    v_exp_f32 v71, v71
    v_exp_f32 v72, v72
    v_exp_f32 v73, v73
    v_exp_f32 v74, v74
    v_exp_f32 v75, v75
    v_cvt_pk_bf16_f32 v96, v68, v69
    v_cvt_pk_bf16_f32 v97, v70, v71
    v_cvt_pk_bf16_f32 v98, v72, v73
    v_cvt_pk_bf16_f32 v99, v74, v75
    v_mfma_f32_32x32x16_bf16 v[60:75], v[140:143], v[20:23], v[28:43]
    v_exp_f32 v76, v76
    v_exp_f32 v77, v77
    v_exp_f32 v78, v78
    v_exp_f32 v79, v79
    v_exp_f32 v80, v80
    v_exp_f32 v81, v81
    v_mfma_f32_32x32x16_bf16 v[108:123], v[184:187], v[96:99], v[108:123]
    v_exp_f32 v82, v82
    v_exp_f32 v83, v83
    v_cvt_pk_bf16_f32 v100, v76, v77
    v_cvt_pk_bf16_f32 v101, v78, v79
    v_cvt_pk_bf16_f32 v102, v80, v81
    v_cvt_pk_bf16_f32 v103, v82, v83
    v_exp_f32 v84, v84
    v_exp_f32 v85, v85
    v_mfma_f32_32x32x16_bf16 v[124:139], v[180:183], v[100:103], v[124:139]
    v_exp_f32 v86, v86
    v_exp_f32 v87, v87
    v_exp_f32 v88, v88
    v_exp_f32 v89, v89
    v_exp_f32 v90, v90
    v_exp_f32 v91, v91
    v_cvt_pk_bf16_f32 v104, v84, v85
    v_cvt_pk_bf16_f32 v105, v86, v87
    v_cvt_pk_bf16_f32 v106, v88, v89
    v_cvt_pk_bf16_f32 v107, v90, v91
    v_mfma_f32_32x32x16_bf16 v[76:91], v[140:143], v[24:27], v[44:59]
    s_waitcnt lgkmcnt(0)
    s_barrier
    v_exp_f32 v60, v60
    v_exp_f32 v61, v61
    v_exp_f32 v62, v62
    v_exp_f32 v63, v63
    v_exp_f32 v64, v64
    v_exp_f32 v65, v65
    v_mfma_f32_32x32x16_bf16 v[124:139], v[184:187], v[104:107], v[124:139]
    s_mov_b64 exec, s[78:79]
    ds_read_b128 v[172:175], v189 offset:12288
    ds_read_b128 v[176:179], v189 offset:12800
    ds_read_b128 v[180:183], v189 offset:14336
    ds_read_b128 v[184:187], v189 offset:14848
    s_mov_b64 exec, -1
    v_exp_f32 v66, v66
    v_exp_f32 v67, v67
    v_cvt_pk_bf16_f32 v92, v60, v61
    v_cvt_pk_bf16_f32 v93, v62, v63
    v_cvt_pk_bf16_f32 v94, v64, v65
    v_cvt_pk_bf16_f32 v95, v66, v67
    v_exp_f32 v68, v68
    v_exp_f32 v69, v69
    v_mfma_f32_32x32x16_bf16 v[108:123], v[156:159], v[92:95], v[108:123]
    v_exp_f32 v70, v70
    v_exp_f32 v71, v71
    v_exp_f32 v72, v72
    v_exp_f32 v73, v73
    v_exp_f32 v74, v74
    v_exp_f32 v75, v75
    v_cvt_pk_bf16_f32 v96, v68, v69
    v_cvt_pk_bf16_f32 v97, v70, v71
    v_cvt_pk_bf16_f32 v98, v72, v73
    v_cvt_pk_bf16_f32 v99, v74, v75
    v_mfma_f32_32x32x16_bf16 v[60:75], v[144:147], v[20:23], v[28:43]
    v_exp_f32 v76, v76
    v_exp_f32 v77, v77
    v_exp_f32 v78, v78
    v_exp_f32 v79, v79
    v_exp_f32 v80, v80
    v_exp_f32 v81, v81
    v_mfma_f32_32x32x16_bf16 v[108:123], v[160:163], v[96:99], v[108:123]
    v_exp_f32 v82, v82
    v_exp_f32 v83, v83
    v_cvt_pk_bf16_f32 v100, v76, v77
    v_cvt_pk_bf16_f32 v101, v78, v79
    v_cvt_pk_bf16_f32 v102, v80, v81
    v_cvt_pk_bf16_f32 v103, v82, v83
    v_exp_f32 v84, v84
    v_exp_f32 v85, v85
    v_mfma_f32_32x32x16_bf16 v[124:139], v[156:159], v[100:103], v[124:139]
    v_exp_f32 v86, v86
    v_exp_f32 v87, v87
    v_exp_f32 v88, v88
    v_exp_f32 v89, v89
    v_exp_f32 v90, v90
    v_exp_f32 v91, v91
    v_cvt_pk_bf16_f32 v104, v84, v85
    v_cvt_pk_bf16_f32 v105, v86, v87
    v_cvt_pk_bf16_f32 v106, v88, v89
    v_cvt_pk_bf16_f32 v107, v90, v91
    v_mfma_f32_32x32x16_bf16 v[76:91], v[144:147], v[24:27], v[44:59]
    ds_read_b128 v[152:155], v188 offset:14336
    ds_read_b128 v[140:143], v188 offset:16384
    v_exp_f32 v60, v60
    v_exp_f32 v61, v61
    v_exp_f32 v62, v62
    v_exp_f32 v63, v63
    v_exp_f32 v64, v64
    v_exp_f32 v65, v65
    v_mfma_f32_32x32x16_bf16 v[124:139], v[160:163], v[104:107], v[124:139]
    v_exp_f32 v66, v66
    v_exp_f32 v67, v67
    v_cvt_pk_bf16_f32 v92, v60, v61
    v_cvt_pk_bf16_f32 v93, v62, v63
    v_cvt_pk_bf16_f32 v94, v64, v65
    v_cvt_pk_bf16_f32 v95, v66, v67
    v_exp_f32 v68, v68
    v_exp_f32 v69, v69
    v_mfma_f32_32x32x16_bf16 v[108:123], v[164:167], v[92:95], v[108:123]
    v_exp_f32 v70, v70
    v_exp_f32 v71, v71
    v_exp_f32 v72, v72
    v_exp_f32 v73, v73
    v_exp_f32 v74, v74
    v_exp_f32 v75, v75
    v_cvt_pk_bf16_f32 v96, v68, v69
    v_cvt_pk_bf16_f32 v97, v70, v71
    v_cvt_pk_bf16_f32 v98, v72, v73
    v_cvt_pk_bf16_f32 v99, v74, v75
    v_mfma_f32_32x32x16_bf16 v[60:75], v[148:151], v[20:23], v[28:43]
    v_exp_f32 v76, v76
    v_exp_f32 v77, v77
    v_exp_f32 v78, v78
    v_exp_f32 v79, v79
    v_exp_f32 v80, v80
    v_exp_f32 v81, v81
    v_mfma_f32_32x32x16_bf16 v[108:123], v[168:171], v[96:99], v[108:123]
    v_exp_f32 v82, v82
    v_exp_f32 v83, v83
    v_cvt_pk_bf16_f32 v100, v76, v77
    v_cvt_pk_bf16_f32 v101, v78, v79
    v_cvt_pk_bf16_f32 v102, v80, v81
    v_cvt_pk_bf16_f32 v103, v82, v83
    v_exp_f32 v84, v84
    v_exp_f32 v85, v85
    v_mfma_f32_32x32x16_bf16 v[124:139], v[164:167], v[100:103], v[124:139]
    v_exp_f32 v86, v86
    v_exp_f32 v87, v87
    v_exp_f32 v88, v88
    v_exp_f32 v89, v89
    v_exp_f32 v90, v90
    v_exp_f32 v91, v91
    v_cvt_pk_bf16_f32 v104, v84, v85
    v_cvt_pk_bf16_f32 v105, v86, v87
    v_cvt_pk_bf16_f32 v106, v88, v89
    v_cvt_pk_bf16_f32 v107, v90, v91
    v_mfma_f32_32x32x16_bf16 v[76:91], v[148:151], v[24:27], v[44:59]
    s_waitcnt lgkmcnt(0)
    v_exp_f32 v60, v60
    v_exp_f32 v61, v61
    v_exp_f32 v62, v62
    v_exp_f32 v63, v63
    v_exp_f32 v64, v64
    v_exp_f32 v65, v65
    v_mfma_f32_32x32x16_bf16 v[124:139], v[168:171], v[104:107], v[124:139]
    s_mov_b64 exec, s[78:79]
    ds_read_b128 v[156:159], v189 offset:16384
    ds_read_b128 v[160:163], v189 offset:16896
    ds_read_b128 v[164:167], v189 offset:18432
    ds_read_b128 v[168:171], v189 offset:18944
    s_mov_b64 exec, -1
    v_exp_f32 v66, v66
    v_exp_f32 v67, v67
    v_cvt_pk_bf16_f32 v92, v60, v61
    v_cvt_pk_bf16_f32 v93, v62, v63
    v_cvt_pk_bf16_f32 v94, v64, v65
    v_cvt_pk_bf16_f32 v95, v66, v67
    v_exp_f32 v68, v68
    v_exp_f32 v69, v69
    v_mfma_f32_32x32x16_bf16 v[108:123], v[172:175], v[92:95], v[108:123]
    v_exp_f32 v70, v70
    v_exp_f32 v71, v71
    v_exp_f32 v72, v72
    v_exp_f32 v73, v73
    v_exp_f32 v74, v74
    v_exp_f32 v75, v75
    v_cvt_pk_bf16_f32 v96, v68, v69
    v_cvt_pk_bf16_f32 v97, v70, v71
    v_cvt_pk_bf16_f32 v98, v72, v73
    v_cvt_pk_bf16_f32 v99, v74, v75
    v_mfma_f32_32x32x16_bf16 v[60:75], v[152:155], v[20:23], v[28:43]
    v_exp_f32 v76, v76
    v_exp_f32 v77, v77
    v_exp_f32 v78, v78
    v_exp_f32 v79, v79
    v_exp_f32 v80, v80
    v_exp_f32 v81, v81
    v_mfma_f32_32x32x16_bf16 v[108:123], v[176:179], v[96:99], v[108:123]
    v_exp_f32 v82, v82
    v_exp_f32 v83, v83
    v_cvt_pk_bf16_f32 v100, v76, v77
    v_cvt_pk_bf16_f32 v101, v78, v79
    v_cvt_pk_bf16_f32 v102, v80, v81
    v_cvt_pk_bf16_f32 v103, v82, v83
    v_exp_f32 v84, v84
    v_exp_f32 v85, v85
    v_mfma_f32_32x32x16_bf16 v[124:139], v[172:175], v[100:103], v[124:139]
    v_exp_f32 v86, v86
    v_exp_f32 v87, v87
    v_exp_f32 v88, v88
    v_exp_f32 v89, v89
    v_exp_f32 v90, v90
    v_exp_f32 v91, v91
    v_cvt_pk_bf16_f32 v104, v84, v85
    v_cvt_pk_bf16_f32 v105, v86, v87
    v_cvt_pk_bf16_f32 v106, v88, v89
    v_cvt_pk_bf16_f32 v107, v90, v91
    v_mfma_f32_32x32x16_bf16 v[76:91], v[152:155], v[24:27], v[44:59]
    ds_read_b128 v[144:147], v188 offset:18432
    ds_read_b128 v[148:151], v188 offset:20480
    v_exp_f32 v60, v60
    v_exp_f32 v61, v61
    v_exp_f32 v62, v62
    v_exp_f32 v63, v63
    v_exp_f32 v64, v64
    v_exp_f32 v65, v65
    v_mfma_f32_32x32x16_bf16 v[124:139], v[176:179], v[104:107], v[124:139]
    v_exp_f32 v66, v66
    v_exp_f32 v67, v67
    v_cvt_pk_bf16_f32 v92, v60, v61
    v_cvt_pk_bf16_f32 v93, v62, v63
    v_cvt_pk_bf16_f32 v94, v64, v65
    v_cvt_pk_bf16_f32 v95, v66, v67
    v_exp_f32 v68, v68
    v_exp_f32 v69, v69
    v_mfma_f32_32x32x16_bf16 v[108:123], v[180:183], v[92:95], v[108:123]
    v_exp_f32 v70, v70
    v_exp_f32 v71, v71
    v_exp_f32 v72, v72
    v_exp_f32 v73, v73
    v_exp_f32 v74, v74
    v_exp_f32 v75, v75
    v_cvt_pk_bf16_f32 v96, v68, v69
    v_cvt_pk_bf16_f32 v97, v70, v71
    v_cvt_pk_bf16_f32 v98, v72, v73
    v_cvt_pk_bf16_f32 v99, v74, v75
    v_mfma_f32_32x32x16_bf16 v[60:75], v[140:143], v[20:23], v[28:43]
    v_exp_f32 v76, v76
    v_exp_f32 v77, v77
    v_exp_f32 v78, v78
    v_exp_f32 v79, v79
    v_exp_f32 v80, v80
    v_exp_f32 v81, v81
    v_mfma_f32_32x32x16_bf16 v[108:123], v[184:187], v[96:99], v[108:123]
    v_exp_f32 v82, v82
    v_exp_f32 v83, v83
    v_cvt_pk_bf16_f32 v100, v76, v77
    v_cvt_pk_bf16_f32 v101, v78, v79
    v_cvt_pk_bf16_f32 v102, v80, v81
    v_cvt_pk_bf16_f32 v103, v82, v83
    v_exp_f32 v84, v84
    v_exp_f32 v85, v85
    v_mfma_f32_32x32x16_bf16 v[124:139], v[180:183], v[100:103], v[124:139]
    v_exp_f32 v86, v86
    v_exp_f32 v87, v87
    v_exp_f32 v88, v88
    v_exp_f32 v89, v89
    v_exp_f32 v90, v90
    v_exp_f32 v91, v91
    v_cvt_pk_bf16_f32 v104, v84, v85
    v_cvt_pk_bf16_f32 v105, v86, v87
    v_cvt_pk_bf16_f32 v106, v88, v89
    v_cvt_pk_bf16_f32 v107, v90, v91
    v_mfma_f32_32x32x16_bf16 v[76:91], v[140:143], v[24:27], v[44:59]
    s_waitcnt lgkmcnt(0)
    s_barrier
    v_exp_f32 v60, v60
    v_exp_f32 v61, v61
    v_exp_f32 v62, v62
    v_exp_f32 v63, v63
    v_exp_f32 v64, v64
    v_exp_f32 v65, v65
    v_mfma_f32_32x32x16_bf16 v[124:139], v[184:187], v[104:107], v[124:139]
    s_mov_b64 exec, s[78:79]
    ds_read_b128 v[172:175], v189 offset:20480
    ds_read_b128 v[176:179], v189 offset:20992
    ds_read_b128 v[180:183], v189 offset:22528
    ds_read_b128 v[184:187], v189 offset:23040
    s_mov_b64 exec, -1
    v_exp_f32 v66, v66
    v_exp_f32 v67, v67
    v_cvt_pk_bf16_f32 v92, v60, v61
    v_cvt_pk_bf16_f32 v93, v62, v63
    v_cvt_pk_bf16_f32 v94, v64, v65
    v_cvt_pk_bf16_f32 v95, v66, v67
    v_exp_f32 v68, v68
    v_exp_f32 v69, v69
    v_mfma_f32_32x32x16_bf16 v[108:123], v[156:159], v[92:95], v[108:123]
    v_exp_f32 v70, v70
    v_exp_f32 v71, v71
    v_exp_f32 v72, v72
    v_exp_f32 v73, v73
    v_exp_f32 v74, v74
    v_exp_f32 v75, v75
    v_cvt_pk_bf16_f32 v96, v68, v69
    v_cvt_pk_bf16_f32 v97, v70, v71
    v_cvt_pk_bf16_f32 v98, v72, v73
    v_cvt_pk_bf16_f32 v99, v74, v75
    v_mfma_f32_32x32x16_bf16 v[60:75], v[144:147], v[20:23], v[28:43]
    v_exp_f32 v76, v76
    v_exp_f32 v77, v77
    v_exp_f32 v78, v78
    v_exp_f32 v79, v79
    v_exp_f32 v80, v80
    v_exp_f32 v81, v81
    v_mfma_f32_32x32x16_bf16 v[108:123], v[160:163], v[96:99], v[108:123]
    v_exp_f32 v82, v82
    v_exp_f32 v83, v83
    v_cvt_pk_bf16_f32 v100, v76, v77
    v_cvt_pk_bf16_f32 v101, v78, v79
    v_cvt_pk_bf16_f32 v102, v80, v81
    v_cvt_pk_bf16_f32 v103, v82, v83
    v_exp_f32 v84, v84
    v_exp_f32 v85, v85
    v_mfma_f32_32x32x16_bf16 v[124:139], v[156:159], v[100:103], v[124:139]
    v_exp_f32 v86, v86
    v_exp_f32 v87, v87
    v_exp_f32 v88, v88
    v_exp_f32 v89, v89
    v_exp_f32 v90, v90
    v_exp_f32 v91, v91
    v_cvt_pk_bf16_f32 v104, v84, v85
    v_cvt_pk_bf16_f32 v105, v86, v87
    v_cvt_pk_bf16_f32 v106, v88, v89
    v_cvt_pk_bf16_f32 v107, v90, v91
    v_mfma_f32_32x32x16_bf16 v[76:91], v[144:147], v[24:27], v[44:59]
    ds_read_b128 v[152:155], v188 offset:22528
    ds_read_b128 v[140:143], v188 offset:24576
    v_exp_f32 v60, v60
    v_exp_f32 v61, v61
    v_exp_f32 v62, v62
    v_exp_f32 v63, v63
    v_exp_f32 v64, v64
    v_exp_f32 v65, v65
    v_mfma_f32_32x32x16_bf16 v[124:139], v[160:163], v[104:107], v[124:139]
    v_exp_f32 v66, v66
    v_exp_f32 v67, v67
    v_cvt_pk_bf16_f32 v92, v60, v61
    v_cvt_pk_bf16_f32 v93, v62, v63
    v_cvt_pk_bf16_f32 v94, v64, v65
    v_cvt_pk_bf16_f32 v95, v66, v67
    v_exp_f32 v68, v68
    v_exp_f32 v69, v69
    v_mfma_f32_32x32x16_bf16 v[108:123], v[164:167], v[92:95], v[108:123]
    v_exp_f32 v70, v70
    v_exp_f32 v71, v71
    v_exp_f32 v72, v72
    v_exp_f32 v73, v73
    v_exp_f32 v74, v74
    v_exp_f32 v75, v75
    v_cvt_pk_bf16_f32 v96, v68, v69
    v_cvt_pk_bf16_f32 v97, v70, v71
    v_cvt_pk_bf16_f32 v98, v72, v73
    v_cvt_pk_bf16_f32 v99, v74, v75
    v_mfma_f32_32x32x16_bf16 v[60:75], v[148:151], v[20:23], v[28:43]
    v_exp_f32 v76, v76
    v_exp_f32 v77, v77
    v_exp_f32 v78, v78
    v_exp_f32 v79, v79
    v_exp_f32 v80, v80
    v_exp_f32 v81, v81
    v_mfma_f32_32x32x16_bf16 v[108:123], v[168:171], v[96:99], v[108:123]
    v_exp_f32 v82, v82
    v_exp_f32 v83, v83
    v_cvt_pk_bf16_f32 v100, v76, v77
    v_cvt_pk_bf16_f32 v101, v78, v79
    v_cvt_pk_bf16_f32 v102, v80, v81
    v_cvt_pk_bf16_f32 v103, v82, v83
    v_exp_f32 v84, v84
    v_exp_f32 v85, v85
    v_mfma_f32_32x32x16_bf16 v[124:139], v[164:167], v[100:103], v[124:139]
    v_exp_f32 v86, v86
    v_exp_f32 v87, v87
    v_exp_f32 v88, v88
    v_exp_f32 v89, v89
    v_exp_f32 v90, v90
    v_exp_f32 v91, v91
    v_cvt_pk_bf16_f32 v104, v84, v85
    v_cvt_pk_bf16_f32 v105, v86, v87
    v_cvt_pk_bf16_f32 v106, v88, v89
    v_cvt_pk_bf16_f32 v107, v90, v91
    v_mfma_f32_32x32x16_bf16 v[76:91], v[148:151], v[24:27], v[44:59]
    s_waitcnt lgkmcnt(0)
    v_exp_f32 v60, v60
    v_exp_f32 v61, v61
    v_exp_f32 v62, v62
    v_exp_f32 v63, v63
    v_exp_f32 v64, v64
    v_exp_f32 v65, v65
    v_mfma_f32_32x32x16_bf16 v[124:139], v[168:171], v[104:107], v[124:139]
    s_mov_b64 exec, s[78:79]
    ds_read_b128 v[156:159], v189 offset:24576
    ds_read_b128 v[160:163], v189 offset:25088
    ds_read_b128 v[164:167], v189 offset:26624
    ds_read_b128 v[168:171], v189 offset:27136
    s_mov_b64 exec, -1
    v_exp_f32 v66, v66
    v_exp_f32 v67, v67
    v_cvt_pk_bf16_f32 v92, v60, v61
    v_cvt_pk_bf16_f32 v93, v62, v63
    v_cvt_pk_bf16_f32 v94, v64, v65
    v_cvt_pk_bf16_f32 v95, v66, v67
    v_exp_f32 v68, v68
    v_exp_f32 v69, v69
    v_mfma_f32_32x32x16_bf16 v[108:123], v[172:175], v[92:95], v[108:123]
    v_exp_f32 v70, v70
    v_exp_f32 v71, v71
    v_exp_f32 v72, v72
    v_exp_f32 v73, v73
    v_exp_f32 v74, v74
    v_exp_f32 v75, v75
    v_cvt_pk_bf16_f32 v96, v68, v69
    v_cvt_pk_bf16_f32 v97, v70, v71
    v_cvt_pk_bf16_f32 v98, v72, v73
    v_cvt_pk_bf16_f32 v99, v74, v75
    v_mfma_f32_32x32x16_bf16 v[60:75], v[152:155], v[20:23], v[28:43]
    v_exp_f32 v76, v76
    v_exp_f32 v77, v77
    v_exp_f32 v78, v78
    v_exp_f32 v79, v79
    v_exp_f32 v80, v80
    v_exp_f32 v81, v81
    v_mfma_f32_32x32x16_bf16 v[108:123], v[176:179], v[96:99], v[108:123]
    v_exp_f32 v82, v82
    v_exp_f32 v83, v83
    v_cvt_pk_bf16_f32 v100, v76, v77
    v_cvt_pk_bf16_f32 v101, v78, v79
    v_cvt_pk_bf16_f32 v102, v80, v81
    v_cvt_pk_bf16_f32 v103, v82, v83
    v_exp_f32 v84, v84
    v_exp_f32 v85, v85
    v_mfma_f32_32x32x16_bf16 v[124:139], v[172:175], v[100:103], v[124:139]
    v_exp_f32 v86, v86
    v_exp_f32 v87, v87
    v_exp_f32 v88, v88
    v_exp_f32 v89, v89
    v_exp_f32 v90, v90
    v_exp_f32 v91, v91
    v_cvt_pk_bf16_f32 v104, v84, v85
    v_cvt_pk_bf16_f32 v105, v86, v87
    v_cvt_pk_bf16_f32 v106, v88, v89
    v_cvt_pk_bf16_f32 v107, v90, v91
    v_mfma_f32_32x32x16_bf16 v[76:91], v[152:155], v[24:27], v[44:59]
    ds_read_b128 v[144:147], v188 offset:26624
    ds_read_b128 v[148:151], v188 offset:28672
    v_exp_f32 v60, v60
    v_exp_f32 v61, v61
    v_exp_f32 v62, v62
    v_exp_f32 v63, v63
    v_exp_f32 v64, v64
    v_exp_f32 v65, v65
    v_mfma_f32_32x32x16_bf16 v[124:139], v[176:179], v[104:107], v[124:139]
    v_exp_f32 v66, v66
    v_exp_f32 v67, v67
    v_cvt_pk_bf16_f32 v92, v60, v61
    v_cvt_pk_bf16_f32 v93, v62, v63
    v_cvt_pk_bf16_f32 v94, v64, v65
    v_cvt_pk_bf16_f32 v95, v66, v67
    v_exp_f32 v68, v68
    v_exp_f32 v69, v69
    v_mfma_f32_32x32x16_bf16 v[108:123], v[180:183], v[92:95], v[108:123]
    v_exp_f32 v70, v70
    v_exp_f32 v71, v71
    v_exp_f32 v72, v72
    v_exp_f32 v73, v73
    v_exp_f32 v74, v74
    v_exp_f32 v75, v75
    v_cvt_pk_bf16_f32 v96, v68, v69
    v_cvt_pk_bf16_f32 v97, v70, v71
    v_cvt_pk_bf16_f32 v98, v72, v73
    v_cvt_pk_bf16_f32 v99, v74, v75
    v_mfma_f32_32x32x16_bf16 v[60:75], v[140:143], v[20:23], v[28:43]
    v_exp_f32 v76, v76
    v_exp_f32 v77, v77
    v_exp_f32 v78, v78
    v_exp_f32 v79, v79
    v_exp_f32 v80, v80
    v_exp_f32 v81, v81
    v_mfma_f32_32x32x16_bf16 v[108:123], v[184:187], v[96:99], v[108:123]
    v_exp_f32 v82, v82
    v_exp_f32 v83, v83
    v_cvt_pk_bf16_f32 v100, v76, v77
    v_cvt_pk_bf16_f32 v101, v78, v79
    v_cvt_pk_bf16_f32 v102, v80, v81
    v_cvt_pk_bf16_f32 v103, v82, v83
    v_exp_f32 v84, v84
    v_exp_f32 v85, v85
    v_mfma_f32_32x32x16_bf16 v[124:139], v[180:183], v[100:103], v[124:139]
    v_exp_f32 v86, v86
    v_exp_f32 v87, v87
    v_exp_f32 v88, v88
    v_exp_f32 v89, v89
    v_exp_f32 v90, v90
    v_exp_f32 v91, v91
    v_cvt_pk_bf16_f32 v104, v84, v85
    v_cvt_pk_bf16_f32 v105, v86, v87
    v_cvt_pk_bf16_f32 v106, v88, v89
    v_cvt_pk_bf16_f32 v107, v90, v91
    v_mfma_f32_32x32x16_bf16 v[76:91], v[140:143], v[24:27], v[44:59]
    s_waitcnt lgkmcnt(0)
    s_barrier
    v_exp_f32 v60, v60
    v_exp_f32 v61, v61
    v_exp_f32 v62, v62
    v_exp_f32 v63, v63
    v_exp_f32 v64, v64
    v_exp_f32 v65, v65
    v_mfma_f32_32x32x16_bf16 v[124:139], v[184:187], v[104:107], v[124:139]
    s_mov_b64 exec, s[78:79]
    ds_read_b128 v[172:175], v189 offset:28672
    ds_read_b128 v[176:179], v189 offset:29184
    ds_read_b128 v[180:183], v189 offset:30720
    ds_read_b128 v[184:187], v189 offset:31232
    s_mov_b64 exec, -1
    v_exp_f32 v66, v66
    v_exp_f32 v67, v67
    v_cvt_pk_bf16_f32 v92, v60, v61
    v_cvt_pk_bf16_f32 v93, v62, v63
    v_cvt_pk_bf16_f32 v94, v64, v65
    v_cvt_pk_bf16_f32 v95, v66, v67
    v_exp_f32 v68, v68
    v_exp_f32 v69, v69
    v_mfma_f32_32x32x16_bf16 v[108:123], v[156:159], v[92:95], v[108:123]
    v_exp_f32 v70, v70
    v_exp_f32 v71, v71
    v_exp_f32 v72, v72
    v_exp_f32 v73, v73
    v_exp_f32 v74, v74
    v_exp_f32 v75, v75
    v_cvt_pk_bf16_f32 v96, v68, v69
    v_cvt_pk_bf16_f32 v97, v70, v71
    v_cvt_pk_bf16_f32 v98, v72, v73
    v_cvt_pk_bf16_f32 v99, v74, v75
    v_mfma_f32_32x32x16_bf16 v[60:75], v[144:147], v[20:23], v[28:43]
    v_exp_f32 v76, v76
    v_exp_f32 v77, v77
    v_exp_f32 v78, v78
    v_exp_f32 v79, v79
    v_exp_f32 v80, v80
    v_exp_f32 v81, v81
    v_mfma_f32_32x32x16_bf16 v[108:123], v[160:163], v[96:99], v[108:123]
    v_exp_f32 v82, v82
    v_exp_f32 v83, v83
    v_cvt_pk_bf16_f32 v100, v76, v77
    v_cvt_pk_bf16_f32 v101, v78, v79
    v_cvt_pk_bf16_f32 v102, v80, v81
    v_cvt_pk_bf16_f32 v103, v82, v83
    v_exp_f32 v84, v84
    v_exp_f32 v85, v85
    v_mfma_f32_32x32x16_bf16 v[124:139], v[156:159], v[100:103], v[124:139]
    v_exp_f32 v86, v86
    v_exp_f32 v87, v87
    v_exp_f32 v88, v88
    v_exp_f32 v89, v89
    v_exp_f32 v90, v90
    v_exp_f32 v91, v91
    v_cvt_pk_bf16_f32 v104, v84, v85
    v_cvt_pk_bf16_f32 v105, v86, v87
    v_cvt_pk_bf16_f32 v106, v88, v89
    v_cvt_pk_bf16_f32 v107, v90, v91
    v_mfma_f32_32x32x16_bf16 v[76:91], v[144:147], v[24:27], v[44:59]
    ds_read_b128 v[152:155], v188 offset:30720
    ds_read_b128 v[140:143], v188 offset:0
    v_exp_f32 v60, v60
    v_exp_f32 v61, v61
    v_exp_f32 v62, v62
    v_exp_f32 v63, v63
    v_exp_f32 v64, v64
    v_exp_f32 v65, v65
    v_mfma_f32_32x32x16_bf16 v[124:139], v[160:163], v[104:107], v[124:139]
    v_exp_f32 v66, v66
    v_exp_f32 v67, v67
    v_cvt_pk_bf16_f32 v92, v60, v61
    v_cvt_pk_bf16_f32 v93, v62, v63
    v_cvt_pk_bf16_f32 v94, v64, v65
    v_cvt_pk_bf16_f32 v95, v66, v67
    v_exp_f32 v68, v68
    v_exp_f32 v69, v69
    v_mfma_f32_32x32x16_bf16 v[108:123], v[164:167], v[92:95], v[108:123]
    v_exp_f32 v70, v70
    v_exp_f32 v71, v71
    v_exp_f32 v72, v72
    v_exp_f32 v73, v73
    v_exp_f32 v74, v74
    v_exp_f32 v75, v75
    v_cvt_pk_bf16_f32 v96, v68, v69
    v_cvt_pk_bf16_f32 v97, v70, v71
    v_cvt_pk_bf16_f32 v98, v72, v73
    v_cvt_pk_bf16_f32 v99, v74, v75
    v_mfma_f32_32x32x16_bf16 v[60:75], v[148:151], v[20:23], v[28:43]
    v_exp_f32 v76, v76
    v_exp_f32 v77, v77
    v_exp_f32 v78, v78
    v_exp_f32 v79, v79
    v_exp_f32 v80, v80
    v_exp_f32 v81, v81
    v_mfma_f32_32x32x16_bf16 v[108:123], v[168:171], v[96:99], v[108:123]
    v_exp_f32 v82, v82
    v_exp_f32 v83, v83
    v_cvt_pk_bf16_f32 v100, v76, v77
    v_cvt_pk_bf16_f32 v101, v78, v79
    v_cvt_pk_bf16_f32 v102, v80, v81
    v_cvt_pk_bf16_f32 v103, v82, v83
    v_exp_f32 v84, v84
    v_exp_f32 v85, v85
    v_mfma_f32_32x32x16_bf16 v[124:139], v[164:167], v[100:103], v[124:139]
    v_exp_f32 v86, v86
    v_exp_f32 v87, v87
    v_exp_f32 v88, v88
    v_exp_f32 v89, v89
    v_exp_f32 v90, v90
    v_exp_f32 v91, v91
    v_cvt_pk_bf16_f32 v104, v84, v85
    v_cvt_pk_bf16_f32 v105, v86, v87
    v_cvt_pk_bf16_f32 v106, v88, v89
    v_cvt_pk_bf16_f32 v107, v90, v91
    v_mfma_f32_32x32x16_bf16 v[76:91], v[148:151], v[24:27], v[44:59]
    s_waitcnt lgkmcnt(0)
    v_exp_f32 v60, v60
    v_exp_f32 v61, v61
    v_exp_f32 v62, v62
    v_exp_f32 v63, v63
    v_exp_f32 v64, v64
    v_exp_f32 v65, v65
    v_mfma_f32_32x32x16_bf16 v[124:139], v[168:171], v[104:107], v[124:139]
    s_mov_b64 exec, s[78:79]
    ds_read_b128 v[156:159], v189 offset:0
    ds_read_b128 v[160:163], v189 offset:512
    ds_read_b128 v[164:167], v189 offset:2048
    ds_read_b128 v[168:171], v189 offset:2560
    s_mov_b64 exec, -1
    v_exp_f32 v66, v66
    v_exp_f32 v67, v67
    v_cvt_pk_bf16_f32 v92, v60, v61
    v_cvt_pk_bf16_f32 v93, v62, v63
    v_cvt_pk_bf16_f32 v94, v64, v65
    v_cvt_pk_bf16_f32 v95, v66, v67
    v_exp_f32 v68, v68
    v_exp_f32 v69, v69
    v_mfma_f32_32x32x16_bf16 v[108:123], v[172:175], v[92:95], v[108:123]
    v_exp_f32 v70, v70
    v_exp_f32 v71, v71
    v_exp_f32 v72, v72
    v_exp_f32 v73, v73
    v_exp_f32 v74, v74
    v_exp_f32 v75, v75
    v_cvt_pk_bf16_f32 v96, v68, v69
    v_cvt_pk_bf16_f32 v97, v70, v71
    v_cvt_pk_bf16_f32 v98, v72, v73
    v_cvt_pk_bf16_f32 v99, v74, v75
    v_mfma_f32_32x32x16_bf16 v[60:75], v[152:155], v[20:23], v[28:43]
    v_exp_f32 v76, v76
    v_exp_f32 v77, v77
    v_exp_f32 v78, v78
    v_exp_f32 v79, v79
    v_exp_f32 v80, v80
    v_exp_f32 v81, v81
    v_mfma_f32_32x32x16_bf16 v[108:123], v[176:179], v[96:99], v[108:123]
    v_exp_f32 v82, v82
    v_exp_f32 v83, v83
    v_cvt_pk_bf16_f32 v100, v76, v77
    v_cvt_pk_bf16_f32 v101, v78, v79
    v_cvt_pk_bf16_f32 v102, v80, v81
    v_cvt_pk_bf16_f32 v103, v82, v83
    v_exp_f32 v84, v84
    v_exp_f32 v85, v85
    v_mfma_f32_32x32x16_bf16 v[124:139], v[172:175], v[100:103], v[124:139]
    v_exp_f32 v86, v86
    v_exp_f32 v87, v87
    v_exp_f32 v88, v88
    v_exp_f32 v89, v89
    v_exp_f32 v90, v90
    v_exp_f32 v91, v91
    v_cvt_pk_bf16_f32 v104, v84, v85
    v_cvt_pk_bf16_f32 v105, v86, v87
    v_cvt_pk_bf16_f32 v106, v88, v89
    v_cvt_pk_bf16_f32 v107, v90, v91
    v_mfma_f32_32x32x16_bf16 v[76:91], v[152:155], v[24:27], v[44:59]
    ds_read_b128 v[144:147], v188 offset:2048
    ds_read_b128 v[148:151], v188 offset:4096
    v_exp_f32 v60, v60
    v_exp_f32 v61, v61
    v_exp_f32 v62, v62
    v_exp_f32 v63, v63
    v_exp_f32 v64, v64
    v_exp_f32 v65, v65
    v_mfma_f32_32x32x16_bf16 v[124:139], v[176:179], v[104:107], v[124:139]
    v_exp_f32 v66, v66
    v_exp_f32 v67, v67
    v_cvt_pk_bf16_f32 v92, v60, v61
    v_cvt_pk_bf16_f32 v93, v62, v63
    v_cvt_pk_bf16_f32 v94, v64, v65
    v_cvt_pk_bf16_f32 v95, v66, v67
    v_exp_f32 v68, v68
    v_exp_f32 v69, v69
    v_mfma_f32_32x32x16_bf16 v[108:123], v[180:183], v[92:95], v[108:123]
    v_exp_f32 v70, v70
    v_exp_f32 v71, v71
    v_exp_f32 v72, v72
    v_exp_f32 v73, v73
    v_exp_f32 v74, v74
    v_exp_f32 v75, v75
    v_cvt_pk_bf16_f32 v96, v68, v69
    v_cvt_pk_bf16_f32 v97, v70, v71
    v_cvt_pk_bf16_f32 v98, v72, v73
    v_cvt_pk_bf16_f32 v99, v74, v75
    v_mfma_f32_32x32x16_bf16 v[60:75], v[140:143], v[20:23], v[28:43]
    v_exp_f32 v76, v76
    v_exp_f32 v77, v77
    v_exp_f32 v78, v78
    v_exp_f32 v79, v79
    v_exp_f32 v80, v80
    v_exp_f32 v81, v81
    v_mfma_f32_32x32x16_bf16 v[108:123], v[184:187], v[96:99], v[108:123]
    v_exp_f32 v82, v82
    v_exp_f32 v83, v83
    v_cvt_pk_bf16_f32 v100, v76, v77
    v_cvt_pk_bf16_f32 v101, v78, v79
    v_cvt_pk_bf16_f32 v102, v80, v81
    v_cvt_pk_bf16_f32 v103, v82, v83
    v_exp_f32 v84, v84
    v_exp_f32 v85, v85
    v_mfma_f32_32x32x16_bf16 v[124:139], v[180:183], v[100:103], v[124:139]
    v_exp_f32 v86, v86
    v_exp_f32 v87, v87
    v_exp_f32 v88, v88
    v_exp_f32 v89, v89
    v_exp_f32 v90, v90
    v_exp_f32 v91, v91
    v_cvt_pk_bf16_f32 v104, v84, v85
    v_cvt_pk_bf16_f32 v105, v86, v87
    v_cvt_pk_bf16_f32 v106, v88, v89
    v_cvt_pk_bf16_f32 v107, v90, v91
    v_mfma_f32_32x32x16_bf16 v[76:91], v[140:143], v[24:27], v[44:59]
    s_waitcnt lgkmcnt(0)
    s_add_u32 s77, s77, 1
    s_cmp_lt_u32 s77, 4
    s_barrier
    s_cbranch_scc1 gated_mix__sliding_local_dilated__grouped_kv_mqa__prompt_kernel_loop
    v_mfma_f32_32x32x16_bf16 v[124:139], v[184:187], v[104:107], v[124:139]
    s_branch gated_mix__sliding_local_dilated__grouped_kv_mqa__prompt_kernel_fin
gated_mix__sliding_local_dilated__grouped_kv_mqa__prompt_kernel_slow:
    s_and_b32 s4, s77, 15
    s_lshl_b32 s4, s4, 11
    v_add_u32 v7, s4, v188
    v_add_u32 v8, s4, v189
    ds_read_b128 v[140:143], v7
    s_mov_b64 exec, s[78:79]
    ds_read_b128 v[156:159], v8
    ds_read_b128 v[160:163], v8 offset:512
    s_mov_b64 exec, -1
    s_waitcnt lgkmcnt(0)
    v_mfma_f32_32x32x16_bf16 v[60:75], v[140:143], v[20:23], 0
    v_mfma_f32_32x32x16_bf16 v[76:91], v[140:143], v[24:27], 0
    s_nop 15
    v_max3_f32 v6, v60, v61, v62
    v_max3_f32 v6, v6, v63, v64
    v_max3_f32 v6, v6, v65, v66
    v_max3_f32 v6, v6, v67, v68
    v_max3_f32 v6, v6, v69, v70
    v_max3_f32 v6, v6, v71, v72
    v_max3_f32 v6, v6, v73, v74
    v_max_f32 v6, v6, v75
    v_mov_b32 v5, v6
    s_nop 1
    v_permlane32_swap_b32 v6, v5
    s_nop 1
    v_max_f32 v6, v6, v5
    v_max_f32 v6, v6, v190
    v_sub_f32 v7, v190, v6
    v_exp_f32 v7, v7
    v_mov_b32 v190, v6
    v_mul_f32 v108, v108, v7
    v_mul_f32 v109, v109, v7
    v_mul_f32 v110, v110, v7
    v_mul_f32 v111, v111, v7
    v_mul_f32 v112, v112, v7
    v_mul_f32 v113, v113, v7
    v_mul_f32 v114, v114, v7
    v_mul_f32 v115, v115, v7
    v_mul_f32 v116, v116, v7
    v_mul_f32 v117, v117, v7
    v_mul_f32 v118, v118, v7
    v_mul_f32 v119, v119, v7
    v_mul_f32 v120, v120, v7
    v_mul_f32 v121, v121, v7
    v_mul_f32 v122, v122, v7
    v_mul_f32 v123, v123, v7
    v_sub_f32 v60, v60, v190
    v_sub_f32 v61, v61, v190
    v_sub_f32 v62, v62, v190
    v_sub_f32 v63, v63, v190
    v_sub_f32 v64, v64, v190
    v_sub_f32 v65, v65, v190
    v_sub_f32 v66, v66, v190
    v_sub_f32 v67, v67, v190
    v_sub_f32 v68, v68, v190
    v_sub_f32 v69, v69, v190
    v_sub_f32 v70, v70, v190
    v_sub_f32 v71, v71, v190
    v_sub_f32 v72, v72, v190
    v_sub_f32 v73, v73, v190
    v_sub_f32 v74, v74, v190
    v_sub_f32 v75, v75, v190
    v_exp_f32 v60, v60
    v_exp_f32 v61, v61
    v_exp_f32 v62, v62
    v_exp_f32 v63, v63
    v_exp_f32 v64, v64
    v_exp_f32 v65, v65
    v_exp_f32 v66, v66
    v_exp_f32 v67, v67
    v_exp_f32 v68, v68
    v_exp_f32 v69, v69
    v_exp_f32 v70, v70
    v_exp_f32 v71, v71
    v_exp_f32 v72, v72
    v_exp_f32 v73, v73
    v_exp_f32 v74, v74
    v_exp_f32 v75, v75
    s_nop 0
    v_cvt_pk_bf16_f32 v92, v60, v61
    v_cvt_pk_bf16_f32 v93, v62, v63
    v_cvt_pk_bf16_f32 v94, v64, v65
    v_cvt_pk_bf16_f32 v95, v66, v67
    v_cvt_pk_bf16_f32 v96, v68, v69
    v_cvt_pk_bf16_f32 v97, v70, v71
    v_cvt_pk_bf16_f32 v98, v72, v73
    v_cvt_pk_bf16_f32 v99, v74, v75
    s_nop 1
    v_mfma_f32_32x32x16_bf16 v[108:123], v[156:159], v[92:95], v[108:123]
    v_mfma_f32_32x32x16_bf16 v[108:123], v[160:163], v[96:99], v[108:123]
    v_max3_f32 v6, v76, v77, v78
    v_max3_f32 v6, v6, v79, v80
    v_max3_f32 v6, v6, v81, v82
    v_max3_f32 v6, v6, v83, v84
    v_max3_f32 v6, v6, v85, v86
    v_max3_f32 v6, v6, v87, v88
    v_max3_f32 v6, v6, v89, v90
    v_max_f32 v6, v6, v91
    v_mov_b32 v5, v6
    s_nop 1
    v_permlane32_swap_b32 v6, v5
    s_nop 1
    v_max_f32 v6, v6, v5
    v_max_f32 v6, v6, v191
    v_sub_f32 v7, v191, v6
    v_exp_f32 v7, v7
    v_mov_b32 v191, v6
    v_mul_f32 v124, v124, v7
    v_mul_f32 v125, v125, v7
    v_mul_f32 v126, v126, v7
    v_mul_f32 v127, v127, v7
    v_mul_f32 v128, v128, v7
    v_mul_f32 v129, v129, v7
    v_mul_f32 v130, v130, v7
    v_mul_f32 v131, v131, v7
    v_mul_f32 v132, v132, v7
    v_mul_f32 v133, v133, v7
    v_mul_f32 v134, v134, v7
    v_mul_f32 v135, v135, v7
    v_mul_f32 v136, v136, v7
    v_mul_f32 v137, v137, v7
    v_mul_f32 v138, v138, v7
    v_mul_f32 v139, v139, v7
    v_sub_f32 v76, v76, v191
    v_sub_f32 v77, v77, v191
    v_sub_f32 v78, v78, v191
    v_sub_f32 v79, v79, v191
    v_sub_f32 v80, v80, v191
    v_sub_f32 v81, v81, v191
    v_sub_f32 v82, v82, v191
    v_sub_f32 v83, v83, v191
    v_sub_f32 v84, v84, v191
    v_sub_f32 v85, v85, v191
    v_sub_f32 v86, v86, v191
    v_sub_f32 v87, v87, v191
    v_sub_f32 v88, v88, v191
    v_sub_f32 v89, v89, v191
    v_sub_f32 v90, v90, v191
    v_sub_f32 v91, v91, v191
    v_exp_f32 v76, v76
    v_exp_f32 v77, v77
    v_exp_f32 v78, v78
    v_exp_f32 v79, v79
    v_exp_f32 v80, v80
    v_exp_f32 v81, v81
    v_exp_f32 v82, v82
    v_exp_f32 v83, v83
    v_exp_f32 v84, v84
    v_exp_f32 v85, v85
    v_exp_f32 v86, v86
    v_exp_f32 v87, v87
    v_exp_f32 v88, v88
    v_exp_f32 v89, v89
    v_exp_f32 v90, v90
    v_exp_f32 v91, v91
    s_nop 0
    v_cvt_pk_bf16_f32 v100, v76, v77
    v_cvt_pk_bf16_f32 v101, v78, v79
    v_cvt_pk_bf16_f32 v102, v80, v81
    v_cvt_pk_bf16_f32 v103, v82, v83
    v_cvt_pk_bf16_f32 v104, v84, v85
    v_cvt_pk_bf16_f32 v105, v86, v87
    v_cvt_pk_bf16_f32 v106, v88, v89
    v_cvt_pk_bf16_f32 v107, v90, v91
    s_nop 1
    v_mfma_f32_32x32x16_bf16 v[124:139], v[156:159], v[100:103], v[124:139]
    v_mfma_f32_32x32x16_bf16 v[124:139], v[160:163], v[104:107], v[124:139]
    s_nop 15
    s_add_u32 s77, s77, 1
    s_and_b32 s4, s77, 3
    s_cmp_lg_u32 s4, 0
    s_cbranch_scc1 gated_mix__sliding_local_dilated__grouped_kv_mqa__prompt_kernel_slow
    s_barrier
    s_cmp_lt_u32 s77, 64
    s_cbranch_scc1 gated_mix__sliding_local_dilated__grouped_kv_mqa__prompt_kernel_slow
gated_mix__sliding_local_dilated__grouped_kv_mqa__prompt_kernel_fin:
    s_and_b32 s4, s3, 1
    s_lshl_b32 s5, s69, 2
    s_and_b32 s6, s3, 2
    s_add_u32 s5, s5, s6
    s_lshl_b32 s6, s4, 5
    s_add_u32 s5, s5, s6
    s_lshl_b32 s5, s5, 10
    s_lshl_b32 s6, s68, 16
    s_add_u32 s6, s6, s5
    s_lshl_b32 s4, s68, 10
    s_lshl_b32 s7, s69, 4
    s_add_u32 s4, s4, s7
    s_lshl_b32 s7, s3, 2
    s_add_u32 s4, s4, s7
    s_add_u32 s6, s6, 3670016
    s_add_u32 s4, s4, 458752
    s_nop 1
    v_rcp_f32 v5, v116
    v_rcp_f32 v6, v132
    v_mul_f32 v108, v108, v5
    v_mul_f32 v109, v109, v5
    v_mul_f32 v110, v110, v5
    v_mul_f32 v111, v111, v5
    v_mul_f32 v112, v112, v5
    v_mul_f32 v113, v113, v5
    v_mul_f32 v114, v114, v5
    v_mul_f32 v115, v115, v5
    v_cvt_pk_bf16_f32 v92, v108, v109
    v_cvt_pk_bf16_f32 v93, v110, v111
    v_cvt_pk_bf16_f32 v94, v112, v113
    v_cvt_pk_bf16_f32 v95, v114, v115
    buffer_store_dwordx4 v[92:95], v4, s[24:27], s6 offen offset:0 sc1
    v_mul_f32 v124, v124, v6
    v_mul_f32 v125, v125, v6
    v_mul_f32 v126, v126, v6
    v_mul_f32 v127, v127, v6
    v_mul_f32 v128, v128, v6
    v_mul_f32 v129, v129, v6
    v_mul_f32 v130, v130, v6
    v_mul_f32 v131, v131, v6
    v_cvt_pk_bf16_f32 v100, v124, v125
    v_cvt_pk_bf16_f32 v101, v126, v127
    v_cvt_pk_bf16_f32 v102, v128, v129
    v_cvt_pk_bf16_f32 v103, v130, v131
    buffer_store_dwordx4 v[100:103], v4, s[24:27], s6 offen offset:1024 sc1
    s_mov_b32 s85, s4
    s_mov_b32 s82, s6
    v_mov_b32 v5, s75
    v_lshrrev_b32 v6, 3, v1
    v_lshlrev_b32 v6, 24, v6
    v_lshl_add_u32 v6, v1, 7, v6
    s_and_b32 s4, s3, 1
    s_lshr_b32 s5, s3, 2
    s_lshl_b32 s5, s5, 1
    s_add_u32 s5, s5, s4
    s_lshl_b32 s4, s68, 16
    s_bfe_u32 s7, s3, 0x10001
    s_lshl_b32 s6, s7, 15
    s_add_u32 s4, s4, s6
    s_lshl_b32 s6, s5, 13
    s_add_u32 s4, s4, s6
    s_add_u32 s84, s4, 3670016
    s_lshl_b32 s4, s5, 14
    s_add_u32 s4, s4, 65536
    v_add_u32 v7, s4, v13
    v_xor_b32 v8, 64, v7
    ds_read_b64_tr_b16 v[140:141], v7 offset:0
    ds_read_b64_tr_b16 v[142:143], v7 offset:1024
    ds_read_b64_tr_b16 v[144:145], v7 offset:2048
    ds_read_b64_tr_b16 v[146:147], v7 offset:3072
    ds_read_b64_tr_b16 v[148:149], v7 offset:4096
    ds_read_b64_tr_b16 v[150:151], v7 offset:5120
    ds_read_b64_tr_b16 v[152:153], v7 offset:6144
    ds_read_b64_tr_b16 v[154:155], v7 offset:7168
    ds_read_b64_tr_b16 v[156:157], v7 offset:8192
    ds_read_b64_tr_b16 v[158:159], v7 offset:9216
    ds_read_b64_tr_b16 v[160:161], v7 offset:10240
    ds_read_b64_tr_b16 v[162:163], v7 offset:11264
    ds_read_b64_tr_b16 v[164:165], v7 offset:12288
    ds_read_b64_tr_b16 v[166:167], v7 offset:13312
    ds_read_b64_tr_b16 v[168:169], v7 offset:14336
    ds_read_b64_tr_b16 v[170:171], v7 offset:15360
    ds_read_b64_tr_b16 v[172:173], v8 offset:0
    ds_read_b64_tr_b16 v[174:175], v8 offset:1024
    ds_read_b64_tr_b16 v[176:177], v8 offset:2048
    ds_read_b64_tr_b16 v[178:179], v8 offset:3072
    ds_read_b64_tr_b16 v[180:181], v8 offset:4096
    ds_read_b64_tr_b16 v[182:183], v8 offset:5120
    ds_read_b64_tr_b16 v[184:185], v8 offset:6144
    ds_read_b64_tr_b16 v[186:187], v8 offset:7168
    ds_read_b64_tr_b16 v[108:109], v8 offset:8192
    ds_read_b64_tr_b16 v[110:111], v8 offset:9216
    ds_read_b64_tr_b16 v[112:113], v8 offset:10240
    ds_read_b64_tr_b16 v[114:115], v8 offset:11264
    ds_read_b64_tr_b16 v[116:117], v8 offset:12288
    ds_read_b64_tr_b16 v[118:119], v8 offset:13312
    ds_read_b64_tr_b16 v[120:121], v8 offset:14336
    ds_read_b64_tr_b16 v[122:123], v8 offset:15360
    s_waitcnt vmcnt(0)
    s_barrier
    s_cmp_lg_u32 s3, 0
    s_cbranch_scc1 gated_mix__sliding_local_dilated__grouped_kv_mqa__prompt_kernel_nof3
    buffer_store_dword v5, v6, s[24:27], s85 offen sc1
gated_mix__sliding_local_dilated__grouped_kv_mqa__prompt_kernel_nof3:
    s_cmp_lg_u32 s3, 0
    s_cbranch_scc1 gated_mix__sliding_local_dilated__grouped_kv_mqa__prompt_kernel_nopoll3
    s_lshl_b32 s83, s68, 10
    s_lshl_b32 s6, s69, 7
    s_add_u32 s83, s83, s6
    s_add_u32 s83, s83, 458752
    v_and_b32 v197, 7, v1
    v_lshlrev_b32 v197, 4, v197
    s_mov_b32 s77, 0
gated_mix__sliding_local_dilated__grouped_kv_mqa__prompt_kernel_att_poll3:
    buffer_load_dword v198, v197, s[24:27], s83 offen sc1
    s_waitcnt vmcnt(0)
gated_mix__sliding_local_dilated__grouped_kv_mqa__prompt_kernel_att_poll3_chk:
    v_cmp_ne_u32 vcc, s75, v198
    s_add_u32 s77, s77, 1
    s_cmp_ge_u32 s77, 200000
    s_cbranch_scc1 gated_mix__sliding_local_dilated__grouped_kv_mqa__prompt_kernel_att_poll3_done
    s_cbranch_vccz gated_mix__sliding_local_dilated__grouped_kv_mqa__prompt_kernel_att_poll3_done
    s_sleep 4
    s_branch gated_mix__sliding_local_dilated__grouped_kv_mqa__prompt_kernel_att_poll3
gated_mix__sliding_local_dilated__grouped_kv_mqa__prompt_kernel_att_poll3_done:
gated_mix__sliding_local_dilated__grouped_kv_mqa__prompt_kernel_nopoll3:
    s_barrier
    s_add_u32 s5, s84, 0
    buffer_load_dwordx4 v[28:31], v4, s[24:27], s5 offen offset:0
    buffer_load_dwordx4 v[32:35], v4, s[24:27], s5 offen offset:1024
    buffer_load_dwordx4 v[36:39], v4, s[24:27], s5 offen offset:2048
    buffer_load_dwordx4 v[40:43], v4, s[24:27], s5 offen offset:3072
    s_add_u32 s5, s84, 4096
    buffer_load_dwordx4 v[44:47], v4, s[24:27], s5 offen offset:0
    buffer_load_dwordx4 v[48:51], v4, s[24:27], s5 offen offset:1024
    buffer_load_dwordx4 v[52:55], v4, s[24:27], s5 offen offset:2048
    buffer_load_dwordx4 v[56:59], v4, s[24:27], s5 offen offset:3072
    s_bfe_u32 s4, s3, 0x10001
    s_mul_i32 s4, s4, 24576
    s_add_u32 s4, s4, 0
    v_add_u32 v8, s4, v4
    s_waitcnt lgkmcnt(0)
    s_waitcnt vmcnt(7)
    v_mfma_f32_32x32x16_bf16 v[60:75], v[140:143], v[28:31], 0
    v_mfma_f32_32x32x16_bf16 v[76:91], v[172:175], v[28:31], 0
    s_waitcnt vmcnt(6)
    v_mfma_f32_32x32x16_bf16 v[60:75], v[144:147], v[32:35], v[60:75]
    v_mfma_f32_32x32x16_bf16 v[76:91], v[176:179], v[32:35], v[76:91]
    s_waitcnt vmcnt(5)
    v_mfma_f32_32x32x16_bf16 v[60:75], v[148:151], v[36:39], v[60:75]
    v_mfma_f32_32x32x16_bf16 v[76:91], v[180:183], v[36:39], v[76:91]
    s_waitcnt vmcnt(4)
    v_mfma_f32_32x32x16_bf16 v[60:75], v[152:155], v[40:43], v[60:75]
    v_mfma_f32_32x32x16_bf16 v[76:91], v[184:187], v[40:43], v[76:91]
    s_waitcnt vmcnt(3)
    v_mfma_f32_32x32x16_bf16 v[60:75], v[156:159], v[44:47], v[60:75]
    v_mfma_f32_32x32x16_bf16 v[76:91], v[108:111], v[44:47], v[76:91]
    s_waitcnt vmcnt(2)
    v_mfma_f32_32x32x16_bf16 v[60:75], v[160:163], v[48:51], v[60:75]
    v_mfma_f32_32x32x16_bf16 v[76:91], v[112:115], v[48:51], v[76:91]
    s_waitcnt vmcnt(1)
    v_mfma_f32_32x32x16_bf16 v[60:75], v[164:167], v[52:55], v[60:75]
    v_mfma_f32_32x32x16_bf16 v[76:91], v[116:119], v[52:55], v[76:91]
    s_waitcnt vmcnt(0)
    v_mfma_f32_32x32x16_bf16 v[60:75], v[168:171], v[56:59], v[60:75]
    v_mfma_f32_32x32x16_bf16 v[76:91], v[120:123], v[56:59], v[76:91]
    s_and_b32 s4, s3, 1
    s_lshl_b32 s4, s4, 12
    v_add_u32 v8, s4, v8
    s_nop 9
    ds_write_b128 v8, v[60:63] offset:0
    ds_write_b128 v8, v[64:67] offset:1024
    ds_write_b128 v8, v[68:71] offset:2048
    ds_write_b128 v8, v[72:75] offset:3072
    ds_write_b128 v8, v[76:79] offset:12288
    ds_write_b128 v8, v[80:83] offset:13312
    ds_write_b128 v8, v[84:87] offset:14336
    ds_write_b128 v8, v[88:91] offset:15360
    s_waitcnt lgkmcnt(0)
    s_barrier
    s_endpgm
gated_mix__sliding_local_dilated__grouped_kv_mqa__prompt_kernel_bg:
    s_sub_u32 s85, s3, 4
    s_mov_b32 s28, s46
    s_mov_b32 s29, s47
    s_mov_b32 s30, 1572864
    s_mov_b32 s31, 0x00020000
    s_mov_b32 s32, s48
    s_mov_b32 s33, s49
    s_mov_b32 s34, 524288
    s_mov_b32 s35, 0x00020000
    s_mov_b32 s36, s58
    s_mov_b32 s37, s59
    s_mov_b32 s38, 524288
    s_mov_b32 s39, 0x00020000
    s_mov_b32 s40, s62
    s_mov_b32 s41, s63
    s_mov_b32 s42, 2097152
    s_mov_b32 s43, 0x00020000
    s_mov_b32 s20, s60
    s_mov_b32 s21, s61
    s_mov_b32 s22, 1024
    s_mov_b32 s23, 0x00020000
    s_lshl_b32 s4, s74, 7
    v_add_u32 v5, s4, v4
    v_and_b32 v5, 1023, v5
    s_mov_b32 m0, 155648
    s_nop 0
    buffer_load_dwordx4 v5, s[20:23], 0 offen lds
    v_bfe_u32 v6, v1, 2, 2
    v_lshlrev_b32 v5, 7, v6
    v_lshrrev_b32 v6, 1, v6
    v_lshl_add_u32 v5, v6, 6, v5
    v_bfe_u32 v6, v1, 4, 1
    v_lshl_add_u32 v5, v6, 5, v5
    v_and_b32 v6, 3, v1
    v_lshl_add_u32 v5, v6, 3, v5
    v_lshl_add_u32 v12, v2, 10, v5
    v_lshl_add_u32 v13, v2, 9, v5
    v_add_u32 v6, 0, v2
    v_bfe_u32 v7, v3, 1, 3
    v_xor_b32 v6, v6, v7
    v_lshlrev_b32 v6, 4, v6
    v_lshl_add_u32 v14, v3, 7, v6
    v_add_u32 v6, 2, v2
    v_bfe_u32 v7, v3, 1, 3
    v_xor_b32 v6, v6, v7
    v_lshlrev_b32 v6, 4, v6
    v_lshl_add_u32 v15, v3, 7, v6
    v_add_u32 v6, 4, v2
    v_bfe_u32 v7, v3, 1, 3
    v_xor_b32 v6, v6, v7
    v_lshlrev_b32 v6, 4, v6
    v_lshl_add_u32 v16, v3, 7, v6
    v_add_u32 v6, 6, v2
    v_bfe_u32 v7, v3, 1, 3
    v_xor_b32 v6, v6, v7
    v_lshlrev_b32 v6, 4, v6
    v_lshl_add_u32 v17, v3, 7, v6
    v_lshlrev_b32 v5, 2, v2
    v_sub_u32 v5, v3, v5
    s_and_b32 s4, s85, 1
    s_or_b32 s4, s68, s4
    s_cmp_eq_u32 s4, 0
    s_cselect_b32 s4, 0x1020, 32
    v_add_u32 v6, s4, v5
    v_mov_b32 v68, 0xf149f2ca
    v_mov_b32 v69, 0
    v_subrev_u32 v72, 0, v5
    v_and_b32 v72, 0xfffffff1, v72
    v_cmp_eq_u32 s[4:5], 0, v72
    v_subrev_u32 v73, 1, v5
    v_and_b32 v73, 0xfffffff1, v73
    v_cmp_eq_u32 s[6:7], 0, v73
    s_nop 1
    v_cndmask_b32 v84, v68, v69, s[4:5]
    v_cndmask_b32 v85, v68, v69, s[6:7]
    v_subrev_u32 v72, 2, v5
    v_and_b32 v72, 0xfffffff1, v72
    v_cmp_eq_u32 s[4:5], 0, v72
    v_subrev_u32 v73, 3, v5
    v_and_b32 v73, 0xfffffff1, v73
    v_cmp_eq_u32 s[6:7], 0, v73
    s_nop 1
    v_cndmask_b32 v86, v68, v69, s[4:5]
    v_cndmask_b32 v87, v68, v69, s[6:7]
    v_subrev_u32 v72, 8, v5
    v_and_b32 v72, 0xfffffff1, v72
    v_cmp_eq_u32 s[4:5], 0, v72
    v_subrev_u32 v73, 9, v5
    v_and_b32 v73, 0xfffffff1, v73
    v_cmp_eq_u32 s[6:7], 0, v73
    s_nop 1
    v_cndmask_b32 v88, v68, v69, s[4:5]
    v_cndmask_b32 v89, v68, v69, s[6:7]
    v_subrev_u32 v72, 10, v5
    v_and_b32 v72, 0xfffffff1, v72
    v_cmp_eq_u32 s[4:5], 0, v72
    v_subrev_u32 v73, 11, v5
    v_and_b32 v73, 0xfffffff1, v73
    v_cmp_eq_u32 s[6:7], 0, v73
    s_nop 1
    v_cndmask_b32 v90, v68, v69, s[4:5]
    v_cndmask_b32 v91, v68, v69, s[6:7]
    v_subrev_u32 v72, 16, v5
    v_and_b32 v72, 0xfffffff1, v72
    v_cmp_eq_u32 s[4:5], 0, v72
    v_subrev_u32 v73, 17, v5
    v_and_b32 v73, 0xfffffff1, v73
    v_cmp_eq_u32 s[6:7], 0, v73
    s_nop 1
    v_cndmask_b32 v92, v68, v69, s[4:5]
    v_cndmask_b32 v93, v68, v69, s[6:7]
    v_subrev_u32 v72, 18, v5
    v_and_b32 v72, 0xfffffff1, v72
    v_cmp_eq_u32 s[4:5], 0, v72
    v_subrev_u32 v73, 19, v5
    v_and_b32 v73, 0xfffffff1, v73
    v_cmp_eq_u32 s[6:7], 0, v73
    s_nop 1
    v_cndmask_b32 v94, v68, v69, s[4:5]
    v_cndmask_b32 v95, v68, v69, s[6:7]
    v_subrev_u32 v72, 24, v5
    v_and_b32 v72, 0xfffffff1, v72
    v_cmp_eq_u32 s[4:5], 0, v72
    v_subrev_u32 v73, 25, v5
    v_and_b32 v73, 0xfffffff1, v73
    v_cmp_eq_u32 s[6:7], 0, v73
    s_nop 1
    v_cndmask_b32 v96, v68, v69, s[4:5]
    v_cndmask_b32 v97, v68, v69, s[6:7]
    v_subrev_u32 v72, 26, v5
    v_and_b32 v72, 0xfffffff1, v72
    v_cmp_eq_u32 s[4:5], 0, v72
    v_subrev_u32 v73, 27, v5
    v_and_b32 v73, 0xfffffff1, v73
    v_cmp_eq_u32 s[6:7], 0, v73
    s_nop 1
    v_cndmask_b32 v98, v68, v69, s[4:5]
    v_cndmask_b32 v99, v68, v69, s[6:7]
    v_subrev_u32 v72, 16, v6
    v_and_b32 v72, 0xfffffff1, v72
    v_cmp_eq_u32 s[4:5], 0, v72
    v_subrev_u32 v73, 17, v6
    v_and_b32 v73, 0xfffffff1, v73
    v_cmp_eq_u32 s[6:7], 0, v73
    s_nop 1
    v_cndmask_b32 v100, v68, v69, s[4:5]
    v_cndmask_b32 v101, v68, v69, s[6:7]
    v_subrev_u32 v72, 18, v6
    v_and_b32 v72, 0xfffffff1, v72
    v_cmp_eq_u32 s[4:5], 0, v72
    v_subrev_u32 v73, 19, v6
    v_and_b32 v73, 0xfffffff1, v73
    v_cmp_eq_u32 s[6:7], 0, v73
    s_nop 1
    v_cndmask_b32 v102, v68, v69, s[4:5]
    v_cndmask_b32 v103, v68, v69, s[6:7]
    v_subrev_u32 v72, 24, v6
    v_and_b32 v72, 0xfffffff1, v72
    v_cmp_eq_u32 s[4:5], 0, v72
    v_subrev_u32 v73, 25, v6
    v_and_b32 v73, 0xfffffff1, v73
    v_cmp_eq_u32 s[6:7], 0, v73
    s_nop 1
    v_cndmask_b32 v104, v68, v69, s[4:5]
    v_cndmask_b32 v105, v68, v69, s[6:7]
    v_subrev_u32 v72, 26, v6
    v_and_b32 v72, 0xfffffff1, v72
    v_cmp_eq_u32 s[4:5], 0, v72
    v_subrev_u32 v73, 27, v6
    v_and_b32 v73, 0xfffffff1, v73
    v_cmp_eq_u32 s[6:7], 0, v73
    s_nop 1
    v_cndmask_b32 v106, v68, v69, s[4:5]
    v_cndmask_b32 v107, v68, v69, s[6:7]
    s_lshr_b32 s4, s85, 1
    s_lshl_b32 s4, s4, 6
    v_xor_b32 v172, s4, v12
    v_add_u32 v172, 81920, v172
    s_and_b32 s4, s85, 1
    s_lshl_b32 s4, s4, 12
    v_add_u32 v173, s4, v14
    v_and_b32 v177, 0xfffff7ff, v14
    v_add_u32 v177, 65536, v177
    v_add_u32 v174, s4, v15
    v_and_b32 v178, 0xfffff7ff, v15
    v_add_u32 v178, 65536, v178
    v_add_u32 v175, s4, v16
    v_and_b32 v179, 0xfffff7ff, v16
    v_add_u32 v179, 65536, v179
    v_add_u32 v176, s4, v17
    v_and_b32 v180, 0xfffff7ff, v17
    v_add_u32 v180, 65536, v180
    v_lshrrev_b32 v5, 3, v1
    v_lshl_add_u32 v128, v5, 11, v11
    s_mul_i32 s4, s85, 49152
    s_lshl_b32 s5, s69, 7
    s_add_u32 s4, s4, s5
    v_add_u32 v128, s4, v128
    v_mul_u32_u24 v181, 3072, v1
    s_min_u32 s4, s85, 2
    s_lshl_b32 s4, s4, 10
    s_lshl_b32 s5, s69, 7
    s_add_u32 s4, s4, s5
    v_add_u32 v181, s4, v181
    s_lshr_b32 s4, s85, 1
    s_lshl_b32 s4, s4, 12
    v_add_u32 v140, s4, v14
    v_add_u32 v141, s4, v15
    v_add_u32 v142, s4, v16
    v_add_u32 v143, s4, v17
    v_lshlrev_b32 v144, 4, v2
    v_add_u32 v144, 155648, v144
    v_mov_b32 v108, 0
    v_mov_b32 v145, 0
    s_waitcnt lgkmcnt(0)
    s_add_u32 s75, s75, 0x9e3779b9
    s_cmp_eq_u32 s85, 0
    s_cbranch_scc1 gated_mix__sliding_local_dilated__grouped_kv_mqa__prompt_kernel_bg_nobulk
    s_add_u32 s6, s72, s85
    s_and_b32 s6, s6, 3
    s_lshl_b32 s81, s6, 14
    s_add_u32 s81, s81, s80
    s_lshl_b32 s82, s6, 11
    s_add_u32 s4, s74, 0
    s_and_b32 s4, s4, 7
    s_lshl_b32 s4, s4, 7
    s_add_u32 s4, s4, s81
    s_add_u32 m0, s82, 0
    s_add_u32 s5, s4, 8192
    buffer_load_dwordx4 v9, s[8:11], s4 offen lds
    s_add_u32 m0, s82, 1024
    s_nop 0
    buffer_load_dwordx4 v10, s[8:11], s5 offen lds
    s_add_u32 s4, s74, 1
    s_and_b32 s4, s4, 7
    s_lshl_b32 s4, s4, 7
    s_add_u32 s4, s4, s81
    s_add_u32 m0, s82, 8192
    s_add_u32 s5, s4, 8192
    buffer_load_dwordx4 v9, s[8:11], s4 offen lds
    s_add_u32 m0, s82, 9216
    s_nop 0
    buffer_load_dwordx4 v10, s[8:11], s5 offen lds
    s_waitcnt vmcnt(4)
    s_barrier
    s_add_u32 s4, s74, 2
    s_and_b32 s4, s4, 7
    s_lshl_b32 s4, s4, 7
    s_add_u32 s4, s4, s81
    s_add_u32 m0, s82, 16384
    s_add_u32 s5, s4, 8192
    buffer_load_dwordx4 v9, s[8:11], s4 offen lds
    s_add_u32 m0, s82, 17408
    s_nop 0
    buffer_load_dwordx4 v10, s[8:11], s5 offen lds
    s_add_u32 s4, s74, 3
    s_and_b32 s4, s4, 7
    s_lshl_b32 s4, s4, 7
    s_add_u32 s4, s4, s81
    s_add_u32 m0, s82, 24576
    s_add_u32 s5, s4, 8192
    buffer_load_dwordx4 v9, s[8:11], s4 offen lds
    s_add_u32 m0, s82, 25600
    s_nop 0
    buffer_load_dwordx4 v10, s[8:11], s5 offen lds
    s_barrier
    s_add_u32 s4, s74, 4
    s_and_b32 s4, s4, 7
    s_lshl_b32 s4, s4, 7
    s_add_u32 s4, s4, s81
    s_add_u32 m0, s82, 32768
    s_add_u32 s5, s4, 8192
    buffer_load_dwordx4 v9, s[8:11], s4 offen lds
    s_add_u32 m0, s82, 33792
    s_nop 0
    buffer_load_dwordx4 v10, s[8:11], s5 offen lds
    s_add_u32 s4, s74, 5
    s_and_b32 s4, s4, 7
    s_lshl_b32 s4, s4, 7
    s_add_u32 s4, s4, s81
    s_add_u32 m0, s82, 40960
    s_add_u32 s5, s4, 8192
    buffer_load_dwordx4 v9, s[8:11], s4 offen lds
    s_add_u32 m0, s82, 41984
    s_nop 0
    buffer_load_dwordx4 v10, s[8:11], s5 offen lds
    s_add_u32 s4, s74, 6
    s_and_b32 s4, s4, 7
    s_lshl_b32 s4, s4, 7
    s_add_u32 s4, s4, s81
    s_add_u32 m0, s82, 49152
    s_add_u32 s5, s4, 8192
    buffer_load_dwordx4 v9, s[8:11], s4 offen lds
    s_add_u32 m0, s82, 50176
    s_nop 0
    buffer_load_dwordx4 v10, s[8:11], s5 offen lds
    s_add_u32 s4, s74, 7
    s_and_b32 s4, s4, 7
    s_lshl_b32 s4, s4, 7
    s_add_u32 s4, s4, s81
    s_add_u32 m0, s82, 57344
    s_add_u32 s5, s4, 8192
    buffer_load_dwordx4 v9, s[8:11], s4 offen lds
    s_add_u32 m0, s82, 58368
    s_nop 0
    buffer_load_dwordx4 v10, s[8:11], s5 offen lds
    s_branch gated_mix__sliding_local_dilated__grouped_kv_mqa__prompt_kernel_bg_nojob
gated_mix__sliding_local_dilated__grouped_kv_mqa__prompt_kernel_bg_nobulk:
    v_and_b32 v5, 15, v1
    v_lshrrev_b32 v6, 1, v5
    v_lshrrev_b32 v7, 4, v1
    v_xor_b32 v6, v6, v7
    v_lshlrev_b32 v6, 4, v6
    v_lshl_add_u32 v6, v5, 7, v6
    s_lshl_b32 s4, s72, 11
    v_add_u32 v28, s4, v6
    v_xor_b32 v29, 64, v28
    v_lshlrev_b32 v7, 8, v7
    v_bfe_u32 v5, v1, 2, 2
    v_lshl_add_u32 v7, v5, 5, v7
    v_and_b32 v5, 3, v1
    v_lshl_add_u32 v7, v5, 3, v7
    v_add_u32 v30, 131072, v7
    s_waitcnt vmcnt(0)
    s_barrier
    ds_read_b128 v[36:39], v28 offset:0
    ds_read_b64_tr_b16 v[52:53], v30 offset:0
    ds_read_b64_tr_b16 v[54:55], v30 offset:128
    ds_read_b128 v[40:43], v29 offset:0
    ds_read_b64_tr_b16 v[56:57], v30 offset:1024
    ds_read_b64_tr_b16 v[58:59], v30 offset:1152
    ds_read_b128 v[44:47], v28 offset:8192
    ds_read_b64_tr_b16 v[60:61], v30 offset:2048
    ds_read_b64_tr_b16 v[62:63], v30 offset:2176
    ds_read_b128 v[48:51], v29 offset:8192
    ds_read_b64_tr_b16 v[64:65], v30 offset:3072
    ds_read_b64_tr_b16 v[66:67], v30 offset:3200
    s_waitcnt lgkmcnt(9)
    v_mfma_f32_16x16x32_bf16 v[20:23], v[52:55], v[36:39], 0
    ds_read_b128 v[36:39], v28 offset:16384
    ds_read_b64_tr_b16 v[52:53], v30 offset:4096
    ds_read_b64_tr_b16 v[54:55], v30 offset:4224
    s_waitcnt lgkmcnt(9)
    v_mfma_f32_16x16x32_bf16 v[32:35], v[56:59], v[40:43], 0
    ds_read_b128 v[40:43], v29 offset:16384
    ds_read_b64_tr_b16 v[56:57], v30 offset:5120
    ds_read_b64_tr_b16 v[58:59], v30 offset:5248
    s_waitcnt lgkmcnt(9)
    v_mfma_f32_16x16x32_bf16 v[20:23], v[60:63], v[44:47], v[20:23]
    ds_read_b128 v[44:47], v28 offset:24576
    ds_read_b64_tr_b16 v[60:61], v30 offset:6144
    ds_read_b64_tr_b16 v[62:63], v30 offset:6272
    s_waitcnt lgkmcnt(9)
    v_mfma_f32_16x16x32_bf16 v[32:35], v[64:67], v[48:51], v[32:35]
    ds_read_b128 v[48:51], v29 offset:24576
    ds_read_b64_tr_b16 v[64:65], v30 offset:7168
    ds_read_b64_tr_b16 v[66:67], v30 offset:7296
    s_waitcnt lgkmcnt(9)
    v_mfma_f32_16x16x32_bf16 v[20:23], v[52:55], v[36:39], v[20:23]
    ds_read_b128 v[36:39], v28 offset:32768
    ds_read_b64_tr_b16 v[52:53], v30 offset:8192
    ds_read_b64_tr_b16 v[54:55], v30 offset:8320
    s_waitcnt lgkmcnt(9)
    v_mfma_f32_16x16x32_bf16 v[32:35], v[56:59], v[40:43], v[32:35]
    ds_read_b128 v[40:43], v29 offset:32768
    ds_read_b64_tr_b16 v[56:57], v30 offset:9216
    ds_read_b64_tr_b16 v[58:59], v30 offset:9344
    s_waitcnt lgkmcnt(9)
    v_mfma_f32_16x16x32_bf16 v[20:23], v[60:63], v[44:47], v[20:23]
    ds_read_b128 v[44:47], v28 offset:40960
    ds_read_b64_tr_b16 v[60:61], v30 offset:10240
    ds_read_b64_tr_b16 v[62:63], v30 offset:10368
    s_waitcnt lgkmcnt(9)
    v_mfma_f32_16x16x32_bf16 v[32:35], v[64:67], v[48:51], v[32:35]
    ds_read_b128 v[48:51], v29 offset:40960
    ds_read_b64_tr_b16 v[64:65], v30 offset:11264
    ds_read_b64_tr_b16 v[66:67], v30 offset:11392
    s_waitcnt lgkmcnt(9)
    v_mfma_f32_16x16x32_bf16 v[20:23], v[52:55], v[36:39], v[20:23]
    ds_read_b128 v[36:39], v28 offset:49152
    ds_read_b64_tr_b16 v[52:53], v30 offset:12288
    ds_read_b64_tr_b16 v[54:55], v30 offset:12416
    s_waitcnt lgkmcnt(9)
    v_mfma_f32_16x16x32_bf16 v[32:35], v[56:59], v[40:43], v[32:35]
    ds_read_b128 v[40:43], v29 offset:49152
    ds_read_b64_tr_b16 v[56:57], v30 offset:13312
    ds_read_b64_tr_b16 v[58:59], v30 offset:13440
    s_waitcnt lgkmcnt(9)
    v_mfma_f32_16x16x32_bf16 v[20:23], v[60:63], v[44:47], v[20:23]
    ds_read_b128 v[44:47], v28 offset:57344
    ds_read_b64_tr_b16 v[60:61], v30 offset:14336
    ds_read_b64_tr_b16 v[62:63], v30 offset:14464
    s_waitcnt lgkmcnt(9)
    v_mfma_f32_16x16x32_bf16 v[32:35], v[64:67], v[48:51], v[32:35]
    ds_read_b128 v[48:51], v29 offset:57344
    ds_read_b64_tr_b16 v[64:65], v30 offset:15360
    ds_read_b64_tr_b16 v[66:67], v30 offset:15488
    s_waitcnt lgkmcnt(9)
    v_mfma_f32_16x16x32_bf16 v[20:23], v[52:55], v[36:39], v[20:23]
    s_waitcnt lgkmcnt(6)
    v_mfma_f32_16x16x32_bf16 v[32:35], v[56:59], v[40:43], v[32:35]
    s_waitcnt lgkmcnt(3)
    v_mfma_f32_16x16x32_bf16 v[20:23], v[60:63], v[44:47], v[20:23]
    s_waitcnt lgkmcnt(0)
    v_mfma_f32_16x16x32_bf16 v[32:35], v[64:67], v[48:51], v[32:35]
    s_lshl_b32 s4, s68, 1
    s_lshr_b32 s5, s72, 1
    s_add_u32 s4, s4, s5
    s_lshl_b32 s4, s4, 11
    s_and_b32 s5, s72, 1
    v_and_b32 v5, 15, v1
    v_bfe_u32 v6, v1, 4, 1
    s_nop 2
    v_add_f32 v20, v20, v32
    v_add_f32 v21, v21, v33
    v_add_f32 v22, v22, v34
    v_add_f32 v23, v23, v35
    v_cvt_pk_bf16_f32 v24, v20, v21
    v_cvt_pk_bf16_f32 v25, v22, v23
    s_cmp_eq_u32 s73, 0
    s_cbranch_scc0 gated_mix__sliding_local_dilated__grouped_kv_mqa__prompt_kernel_vkind
    s_lshl_b32 s5, s5, 8
    s_add_u32 s4, s4, s5
    v_lshlrev_b32 v7, 4, v5
    v_lshl_add_u32 v7, v6, 9, v7
    v_lshl_add_u32 v7, v2, 3, v7
    buffer_store_dwordx2 v[24:25], v7, s[24:27], s4 offen sc1
    v_mul_f32 v27, v20, v20
    v_fmac_f32 v27, v21, v21
    v_fmac_f32 v27, v22, v22
    v_fmac_f32 v27, v23, v23
    v_mov_b32 v8, v27
    s_nop 1
    v_permlane16_swap_b32 v27, v8
    s_nop 1
    v_add_f32 v27, v27, v8
    v_mov_b32 v8, v27
    s_nop 1
    v_permlane32_swap_b32 v27, v8
    s_nop 1
    v_add_f32 v27, v27, v8
    s_branch gated_mix__sliding_local_dilated__grouped_kv_mqa__prompt_kernel_jdone
gated_mix__sliding_local_dilated__grouped_kv_mqa__prompt_kernel_vkind:
    s_lshl_b32 s5, s5, 9
    s_add_u32 s4, s4, s5
    s_add_u32 s4, s4, 1024
    v_bfe_u32 v7, v5, 2, 1
    v_lshlrev_b32 v7, 8, v7
    v_lshrrev_b32 v8, 4, v1
    v_lshl_add_u32 v7, v8, 6, v7
    v_and_b32 v8, 3, v5
    v_lshl_add_u32 v7, v8, 1, v7
    v_lshrrev_b32 v8, 3, v5
    v_lshl_add_u32 v7, v8, 3, v7
    buffer_store_short v24, v7, s[24:27], s4 offen sc1
    buffer_store_short_d16_hi v24, v7, s[24:27], s4 offen offset:16 sc1
    buffer_store_short v25, v7, s[24:27], s4 offen offset:32 sc1
    buffer_store_short_d16_hi v25, v7, s[24:27], s4 offen offset:48 sc1
    v_max_f32 v27, abs(v20), abs(v21)
    v_max3_f32 v27, v27, abs(v22), abs(v23)
    v_mov_b32 v8, v27
    s_nop 1
    v_permlane16_swap_b32 v27, v8
    s_nop 1
    v_max_f32 v27, v27, v8
    v_mov_b32 v8, v27
    s_nop 1
    v_permlane32_swap_b32 v27, v8
    s_nop 1
    v_max_f32 v27, v27, v8
gated_mix__sliding_local_dilated__grouped_kv_mqa__prompt_kernel_jdone:
    s_barrier
    s_nop 1
    v_max_f32_dpp v27, v27, v27 row_ror:8 row_mask:0xf bank_mask:0xf
    s_nop 1
    v_max_f32_dpp v27, v27, v27 row_ror:4 row_mask:0xf bank_mask:0xf
    s_nop 1
    v_max_f32_dpp v27, v27, v27 row_ror:2 row_mask:0xf bank_mask:0xf
    s_nop 1
    v_max_f32_dpp v27, v27, v27 row_ror:1 row_mask:0xf bank_mask:0xf
    v_mov_b32 v26, s75
    s_lshl_b32 s4, s68, 6
    s_lshl_b32 s5, s69, 3
    s_add_u32 s4, s4, s5
    s_add_u32 s4, s4, 262144
    v_lshlrev_b32 v6, 11, v1
    s_waitcnt vmcnt(0)
    buffer_store_dwordx2 v[26:27], v6, s[24:27], s4 offen sc1
    s_branch gated_mix__sliding_local_dilated__grouped_kv_mqa__prompt_kernel_bg_join
gated_mix__sliding_local_dilated__grouped_kv_mqa__prompt_kernel_bg_nojob:
gated_mix__sliding_local_dilated__grouped_kv_mqa__prompt_kernel_bg_join:
    s_waitcnt vmcnt(8)
    s_barrier
    ds_read_b128 v[36:39], v140 offset:0
    ds_read_b128 v[52:55], v144 offset:0
    ds_read_b128 v[40:43], v141 offset:0
    ds_read_b128 v[56:59], v144 offset:32
    ds_read_b128 v[44:47], v142 offset:0
    ds_read_b128 v[60:63], v144 offset:64
    ds_read_b128 v[48:51], v143 offset:0
    ds_read_b128 v[64:67], v144 offset:96
    s_waitcnt lgkmcnt(6)
    v_dot2_f32_bf16 v108, v36, v52, v108
    v_dot2_f32_bf16 v145, v37, v53, v145
    v_dot2_f32_bf16 v108, v38, v54, v108
    v_dot2_f32_bf16 v145, v39, v55, v145
    ds_read_b128 v[36:39], v140 offset:8192
    ds_read_b128 v[52:55], v144 offset:128
    s_waitcnt lgkmcnt(6)
    v_dot2_f32_bf16 v108, v40, v56, v108
    v_dot2_f32_bf16 v145, v41, v57, v145
    v_dot2_f32_bf16 v108, v42, v58, v108
    v_dot2_f32_bf16 v145, v43, v59, v145
    ds_read_b128 v[40:43], v141 offset:8192
    ds_read_b128 v[56:59], v144 offset:160
    s_waitcnt lgkmcnt(6)
    v_dot2_f32_bf16 v108, v44, v60, v108
    v_dot2_f32_bf16 v145, v45, v61, v145
    v_dot2_f32_bf16 v108, v46, v62, v108
    v_dot2_f32_bf16 v145, v47, v63, v145
    ds_read_b128 v[44:47], v142 offset:8192
    ds_read_b128 v[60:63], v144 offset:192
    s_waitcnt lgkmcnt(6)
    v_dot2_f32_bf16 v108, v48, v64, v108
    v_dot2_f32_bf16 v145, v49, v65, v145
    v_dot2_f32_bf16 v108, v50, v66, v108
    v_dot2_f32_bf16 v145, v51, v67, v145
    ds_read_b128 v[48:51], v143 offset:8192
    ds_read_b128 v[64:67], v144 offset:224
    s_waitcnt lgkmcnt(6)
    v_dot2_f32_bf16 v108, v36, v52, v108
    v_dot2_f32_bf16 v145, v37, v53, v145
    v_dot2_f32_bf16 v108, v38, v54, v108
    v_dot2_f32_bf16 v145, v39, v55, v145
    ds_read_b128 v[36:39], v140 offset:16384
    ds_read_b128 v[52:55], v144 offset:256
    s_waitcnt lgkmcnt(6)
    v_dot2_f32_bf16 v108, v40, v56, v108
    v_dot2_f32_bf16 v145, v41, v57, v145
    v_dot2_f32_bf16 v108, v42, v58, v108
    v_dot2_f32_bf16 v145, v43, v59, v145
    ds_read_b128 v[40:43], v141 offset:16384
    ds_read_b128 v[56:59], v144 offset:288
    s_waitcnt lgkmcnt(6)
    v_dot2_f32_bf16 v108, v44, v60, v108
    v_dot2_f32_bf16 v145, v45, v61, v145
    v_dot2_f32_bf16 v108, v46, v62, v108
    v_dot2_f32_bf16 v145, v47, v63, v145
    ds_read_b128 v[44:47], v142 offset:16384
    ds_read_b128 v[60:63], v144 offset:320
    s_waitcnt lgkmcnt(6)
    v_dot2_f32_bf16 v108, v48, v64, v108
    v_dot2_f32_bf16 v145, v49, v65, v145
    v_dot2_f32_bf16 v108, v50, v66, v108
    v_dot2_f32_bf16 v145, v51, v67, v145
    ds_read_b128 v[48:51], v143 offset:16384
    ds_read_b128 v[64:67], v144 offset:352
    s_waitcnt lgkmcnt(6)
    v_dot2_f32_bf16 v108, v36, v52, v108
    v_dot2_f32_bf16 v145, v37, v53, v145
    v_dot2_f32_bf16 v108, v38, v54, v108
    v_dot2_f32_bf16 v145, v39, v55, v145
    ds_read_b128 v[36:39], v140 offset:24576
    ds_read_b128 v[52:55], v144 offset:384
    s_waitcnt lgkmcnt(6)
    v_dot2_f32_bf16 v108, v40, v56, v108
    v_dot2_f32_bf16 v145, v41, v57, v145
    v_dot2_f32_bf16 v108, v42, v58, v108
    v_dot2_f32_bf16 v145, v43, v59, v145
    ds_read_b128 v[40:43], v141 offset:24576
    ds_read_b128 v[56:59], v144 offset:416
    s_waitcnt lgkmcnt(6)
    v_dot2_f32_bf16 v108, v44, v60, v108
    v_dot2_f32_bf16 v145, v45, v61, v145
    v_dot2_f32_bf16 v108, v46, v62, v108
    v_dot2_f32_bf16 v145, v47, v63, v145
    ds_read_b128 v[44:47], v142 offset:24576
    ds_read_b128 v[60:63], v144 offset:448
    s_waitcnt lgkmcnt(6)
    v_dot2_f32_bf16 v108, v48, v64, v108
    v_dot2_f32_bf16 v145, v49, v65, v145
    v_dot2_f32_bf16 v108, v50, v66, v108
    v_dot2_f32_bf16 v145, v51, v67, v145
    ds_read_b128 v[48:51], v143 offset:24576
    ds_read_b128 v[64:67], v144 offset:480
    s_waitcnt lgkmcnt(6)
    v_dot2_f32_bf16 v108, v36, v52, v108
    v_dot2_f32_bf16 v145, v37, v53, v145
    v_dot2_f32_bf16 v108, v38, v54, v108
    v_dot2_f32_bf16 v145, v39, v55, v145
    s_waitcnt lgkmcnt(4)
    v_dot2_f32_bf16 v108, v40, v56, v108
    v_dot2_f32_bf16 v145, v41, v57, v145
    v_dot2_f32_bf16 v108, v42, v58, v108
    v_dot2_f32_bf16 v145, v43, v59, v145
    s_waitcnt lgkmcnt(2)
    v_dot2_f32_bf16 v108, v44, v60, v108
    v_dot2_f32_bf16 v145, v45, v61, v145
    v_dot2_f32_bf16 v108, v46, v62, v108
    v_dot2_f32_bf16 v145, v47, v63, v145
    s_waitcnt lgkmcnt(0)
    v_dot2_f32_bf16 v108, v48, v64, v108
    v_dot2_f32_bf16 v145, v49, v65, v145
    v_dot2_f32_bf16 v108, v50, v66, v108
    v_dot2_f32_bf16 v145, v51, v67, v145
    s_waitcnt vmcnt(0)
    s_barrier
    s_barrier
    ds_read_b128 v[36:39], v140 offset:32768
    ds_read_b128 v[52:55], v144 offset:512
    ds_read_b128 v[40:43], v141 offset:32768
    ds_read_b128 v[56:59], v144 offset:544
    ds_read_b128 v[44:47], v142 offset:32768
    ds_read_b128 v[60:63], v144 offset:576
    ds_read_b128 v[48:51], v143 offset:32768
    ds_read_b128 v[64:67], v144 offset:608
    s_waitcnt lgkmcnt(6)
    v_dot2_f32_bf16 v108, v36, v52, v108
    v_dot2_f32_bf16 v145, v37, v53, v145
    v_dot2_f32_bf16 v108, v38, v54, v108
    v_dot2_f32_bf16 v145, v39, v55, v145
    ds_read_b128 v[36:39], v140 offset:40960
    ds_read_b128 v[52:55], v144 offset:640
    s_waitcnt lgkmcnt(6)
    v_dot2_f32_bf16 v108, v40, v56, v108
    v_dot2_f32_bf16 v145, v41, v57, v145
    v_dot2_f32_bf16 v108, v42, v58, v108
    v_dot2_f32_bf16 v145, v43, v59, v145
    ds_read_b128 v[40:43], v141 offset:40960
    ds_read_b128 v[56:59], v144 offset:672
    s_waitcnt lgkmcnt(6)
    v_dot2_f32_bf16 v108, v44, v60, v108
    v_dot2_f32_bf16 v145, v45, v61, v145
    v_dot2_f32_bf16 v108, v46, v62, v108
    v_dot2_f32_bf16 v145, v47, v63, v145
    ds_read_b128 v[44:47], v142 offset:40960
    ds_read_b128 v[60:63], v144 offset:704
    s_waitcnt lgkmcnt(6)
    v_dot2_f32_bf16 v108, v48, v64, v108
    v_dot2_f32_bf16 v145, v49, v65, v145
    v_dot2_f32_bf16 v108, v50, v66, v108
    v_dot2_f32_bf16 v145, v51, v67, v145
    ds_read_b128 v[48:51], v143 offset:40960
    ds_read_b128 v[64:67], v144 offset:736
    s_waitcnt lgkmcnt(6)
    v_dot2_f32_bf16 v108, v36, v52, v108
    v_dot2_f32_bf16 v145, v37, v53, v145
    v_dot2_f32_bf16 v108, v38, v54, v108
    v_dot2_f32_bf16 v145, v39, v55, v145
    ds_read_b128 v[36:39], v140 offset:49152
    ds_read_b128 v[52:55], v144 offset:768
    s_waitcnt lgkmcnt(6)
    v_dot2_f32_bf16 v108, v40, v56, v108
    v_dot2_f32_bf16 v145, v41, v57, v145
    v_dot2_f32_bf16 v108, v42, v58, v108
    v_dot2_f32_bf16 v145, v43, v59, v145
    ds_read_b128 v[40:43], v141 offset:49152
    ds_read_b128 v[56:59], v144 offset:800
    s_waitcnt lgkmcnt(6)
    v_dot2_f32_bf16 v108, v44, v60, v108
    v_dot2_f32_bf16 v145, v45, v61, v145
    v_dot2_f32_bf16 v108, v46, v62, v108
    v_dot2_f32_bf16 v145, v47, v63, v145
    ds_read_b128 v[44:47], v142 offset:49152
    ds_read_b128 v[60:63], v144 offset:832
    s_waitcnt lgkmcnt(6)
    v_dot2_f32_bf16 v108, v48, v64, v108
    v_dot2_f32_bf16 v145, v49, v65, v145
    v_dot2_f32_bf16 v108, v50, v66, v108
    v_dot2_f32_bf16 v145, v51, v67, v145
    ds_read_b128 v[48:51], v143 offset:49152
    ds_read_b128 v[64:67], v144 offset:864
    s_waitcnt lgkmcnt(6)
    v_dot2_f32_bf16 v108, v36, v52, v108
    v_dot2_f32_bf16 v145, v37, v53, v145
    v_dot2_f32_bf16 v108, v38, v54, v108
    v_dot2_f32_bf16 v145, v39, v55, v145
    ds_read_b128 v[36:39], v140 offset:57344
    ds_read_b128 v[52:55], v144 offset:896
    s_waitcnt lgkmcnt(6)
    v_dot2_f32_bf16 v108, v40, v56, v108
    v_dot2_f32_bf16 v145, v41, v57, v145
    v_dot2_f32_bf16 v108, v42, v58, v108
    v_dot2_f32_bf16 v145, v43, v59, v145
    ds_read_b128 v[40:43], v141 offset:57344
    ds_read_b128 v[56:59], v144 offset:928
    s_waitcnt lgkmcnt(6)
    v_dot2_f32_bf16 v108, v44, v60, v108
    v_dot2_f32_bf16 v145, v45, v61, v145
    v_dot2_f32_bf16 v108, v46, v62, v108
    v_dot2_f32_bf16 v145, v47, v63, v145
    ds_read_b128 v[44:47], v142 offset:57344
    ds_read_b128 v[60:63], v144 offset:960
    s_waitcnt lgkmcnt(6)
    v_dot2_f32_bf16 v108, v48, v64, v108
    v_dot2_f32_bf16 v145, v49, v65, v145
    v_dot2_f32_bf16 v108, v50, v66, v108
    v_dot2_f32_bf16 v145, v51, v67, v145
    ds_read_b128 v[48:51], v143 offset:57344
    ds_read_b128 v[64:67], v144 offset:992
    s_waitcnt lgkmcnt(6)
    v_dot2_f32_bf16 v108, v36, v52, v108
    v_dot2_f32_bf16 v145, v37, v53, v145
    v_dot2_f32_bf16 v108, v38, v54, v108
    v_dot2_f32_bf16 v145, v39, v55, v145
    s_waitcnt lgkmcnt(4)
    v_dot2_f32_bf16 v108, v40, v56, v108
    v_dot2_f32_bf16 v145, v41, v57, v145
    v_dot2_f32_bf16 v108, v42, v58, v108
    v_dot2_f32_bf16 v145, v43, v59, v145
    s_waitcnt lgkmcnt(2)
    v_dot2_f32_bf16 v108, v44, v60, v108
    v_dot2_f32_bf16 v145, v45, v61, v145
    v_dot2_f32_bf16 v108, v46, v62, v108
    v_dot2_f32_bf16 v145, v47, v63, v145
    s_waitcnt lgkmcnt(0)
    v_dot2_f32_bf16 v108, v48, v64, v108
    v_dot2_f32_bf16 v145, v49, v65, v145
    v_dot2_f32_bf16 v108, v50, v66, v108
    v_dot2_f32_bf16 v145, v51, v67, v145
    s_lshl_b32 s83, s85, 10
    s_lshl_b32 s84, s85, 11
    s_nop 4
    v_add_f32 v108, v108, v145
    v_mov_b32 v5, v108
    s_nop 1
    v_permlane32_swap_b32 v108, v5
    s_nop 1
    v_add_f32 v108, v108, v5
    v_mul_f32 v108, 0xbfb8aa3b, v108
    v_exp_f32 v108, v108
    s_nop 0
    v_add_f32 v108, 1.0, v108
    v_rcp_f32 v108, v108
    s_and_b32 s4, s85, 1
    s_sub_u32 s70, 0, s4
    s_mov_b32 s71, s70
    s_barrier
    s_add_u32 m0, s83, 155648
    s_add_u32 s5, s83, 24576
    buffer_load_dwordx4 v4, s[24:27], s5 offen lds
    s_add_u32 m0, s83, 159744
    s_add_u32 s5, s83, 28672
    buffer_load_dwordx4 v4, s[24:27], s5 offen lds
    s_add_u32 s6, s74, 0
    s_and_b32 s6, s6, 7
    s_mul_i32 s7, s6, 196608
    s_add_u32 m0, s84, 81920
    s_add_u32 s5, s7, 0
    buffer_load_dwordx4 v128, s[28:31], s5 offen lds
    s_add_u32 m0, s84, 82944
    s_add_u32 s5, s7, 24576
    buffer_load_dwordx4 v128, s[28:31], s5 offen lds
    s_add_u32 m0, s84, 90112
    s_add_u32 s5, s7, 1024
    buffer_load_dwordx4 v128, s[28:31], s5 offen lds
    s_add_u32 m0, s84, 91136
    s_add_u32 s5, s7, 25600
    buffer_load_dwordx4 v128, s[28:31], s5 offen lds
    s_add_u32 m0, s84, 98304
    s_add_u32 s5, s7, 2048
    buffer_load_dwordx4 v128, s[28:31], s5 offen lds
    s_add_u32 m0, s84, 99328
    s_add_u32 s5, s7, 26624
    buffer_load_dwordx4 v128, s[28:31], s5 offen lds
    s_sub_u32 s4, s80, 16384
    s_cmp_eq_u32 s68, 0
    s_cselect_b32 s4, 0, s4
    s_lshl_b32 s6, s85, 1
    s_add_u32 s6, s6, s74
    s_and_b32 s6, s6, 7
    s_lshl_b32 s6, s6, 7
    s_add_u32 s6, s6, s4
    s_lshl_b32 s7, s85, 12
    s_add_u32 m0, s7, 65536
    s_add_u32 s5, s6, 8192
    buffer_load_dwordx4 v9, s[8:11], s6 offen lds
    s_add_u32 m0, s7, 66560
    s_nop 0
    buffer_load_dwordx4 v10, s[8:11], s5 offen lds
    s_lshl_b32 s6, s85, 1
    s_add_u32 s6, s6, s74
    s_add_u32 s6, s6, 1
    s_and_b32 s6, s6, 7
    s_lshl_b32 s6, s6, 7
    s_add_u32 s6, s6, s4
    s_lshl_b32 s7, s85, 12
    s_add_u32 m0, s7, 67584
    s_add_u32 s5, s6, 8192
    buffer_load_dwordx4 v9, s[8:11], s6 offen lds
    s_add_u32 m0, s7, 68608
    s_nop 0
    buffer_load_dwordx4 v10, s[8:11], s5 offen lds
    s_or_b32 s4, s2, s85
    s_cmp_lg_u32 s4, 0
    s_cbranch_scc1 gated_mix__sliding_local_dilated__grouped_kv_mqa__prompt_kernel_noep
    v_mov_b32 v7, s75
    v_lshlrev_b32 v6, 24, v1
    s_mov_b32 s4, 131072
    buffer_store_dword v7, v6, s[24:27], s4 offen sc1
    s_waitcnt vmcnt(0)
gated_mix__sliding_local_dilated__grouped_kv_mqa__prompt_kernel_noep:
    s_waitcnt lgkmcnt(0)
    s_barrier
    s_add_u32 m0, s83, 131072
    s_add_u32 s5, s83, 32768
    buffer_load_dwordx4 v4, s[24:27], s5 offen lds
    s_add_u32 m0, s83, 135168
    s_add_u32 s5, s83, 36864
    buffer_load_dwordx4 v4, s[24:27], s5 offen lds
    s_add_u32 s6, s74, 1
    s_and_b32 s6, s6, 7
    s_mul_i32 s7, s6, 196608
    s_add_u32 m0, s84, 106496
    s_add_u32 s5, s7, 0
    buffer_load_dwordx4 v128, s[28:31], s5 offen lds
    s_add_u32 m0, s84, 107520
    s_add_u32 s5, s7, 24576
    buffer_load_dwordx4 v128, s[28:31], s5 offen lds
    s_add_u32 m0, s84, 114688
    s_add_u32 s5, s7, 1024
    buffer_load_dwordx4 v128, s[28:31], s5 offen lds
    s_add_u32 m0, s84, 115712
    s_add_u32 s5, s7, 25600
    buffer_load_dwordx4 v128, s[28:31], s5 offen lds
    s_add_u32 m0, s84, 122880
    s_add_u32 s5, s7, 2048
    buffer_load_dwordx4 v128, s[28:31], s5 offen lds
    s_add_u32 m0, s84, 123904
    s_add_u32 s5, s7, 26624
    buffer_load_dwordx4 v128, s[28:31], s5 offen lds
    s_waitcnt vmcnt(18)
    s_waitcnt lgkmcnt(0)
    s_barrier
    s_add_u32 m0, s83, 139264
    s_add_u32 s5, s83, 40960
    buffer_load_dwordx4 v4, s[24:27], s5 offen lds
    s_add_u32 m0, s83, 143360
    s_add_u32 s5, s83, 45056
    buffer_load_dwordx4 v4, s[24:27], s5 offen lds
    s_waitcnt vmcnt(8)
    s_waitcnt lgkmcnt(0)
    s_barrier
    s_add_u32 m0, s83, 147456
    s_add_u32 s5, s83, 49152
    buffer_load_dwordx4 v4, s[24:27], s5 offen lds
    s_add_u32 m0, s83, 151552
    s_add_u32 s5, s83, 53248
    buffer_load_dwordx4 v4, s[24:27], s5 offen lds
    s_mov_b64 vcc, s[70:71]
    ds_read_b128 v[132:135], v173 offset:0
    ds_read_b64_tr_b16 v[148:149], v172 offset:0
    ds_read_b64_tr_b16 v[150:151], v172 offset:512
    ds_read_b64_tr_b16 v[152:153], v172 offset:8192
    ds_read_b64_tr_b16 v[154:155], v172 offset:8704
    ds_read_b64_tr_b16 v[156:157], v172 offset:16384
    ds_read_b64_tr_b16 v[158:159], v172 offset:16896
    ds_read_b128 v[140:143], v177 offset:0
    ds_read_b128 v[136:139], v174 offset:0
    ds_read_b64_tr_b16 v[160:161], v172 offset:2048
    ds_read_b64_tr_b16 v[162:163], v172 offset:2560
    ds_read_b64_tr_b16 v[164:165], v172 offset:10240
    ds_read_b64_tr_b16 v[166:167], v172 offset:10752
    ds_read_b64_tr_b16 v[168:169], v172 offset:18432
    ds_read_b64_tr_b16 v[170:171], v172 offset:18944
    ds_read_b128 v[144:147], v178 offset:0
    s_waitcnt lgkmcnt(13)
    v_mfma_f32_32x32x16_bf16 v[20:35], v[148:151], v[132:135], 0
    s_waitcnt lgkmcnt(11)
    v_mfma_f32_32x32x16_bf16 v[36:51], v[152:155], v[132:135], 0
    s_waitcnt lgkmcnt(9)
    v_mfma_f32_32x32x16_bf16 v[52:67], v[132:135], v[156:159], 0
    s_waitcnt lgkmcnt(8)
    s_cbranch_vccnz gated_mix__sliding_local_dilated__grouped_kv_mqa__prompt_kernel_hv1
    v_mfma_f32_32x32x16_bf16 v[68:83], v[152:155], v[140:143], 0
    s_branch gated_mix__sliding_local_dilated__grouped_kv_mqa__prompt_kernel_hd1
gated_mix__sliding_local_dilated__grouped_kv_mqa__prompt_kernel_hv1:
    v_mfma_f32_32x32x16_bf16 v[68:83], v[140:143], v[156:159], 0
gated_mix__sliding_local_dilated__grouped_kv_mqa__prompt_kernel_hd1:
    ds_read_b128 v[132:135], v175 offset:0
    ds_read_b64_tr_b16 v[148:149], v172 offset:4096
    ds_read_b64_tr_b16 v[150:151], v172 offset:4608
    ds_read_b64_tr_b16 v[152:153], v172 offset:12288
    ds_read_b64_tr_b16 v[154:155], v172 offset:12800
    ds_read_b64_tr_b16 v[156:157], v172 offset:20480
    ds_read_b64_tr_b16 v[158:159], v172 offset:20992
    ds_read_b128 v[140:143], v179 offset:0
    s_waitcnt lgkmcnt(13)
    v_mfma_f32_32x32x16_bf16 v[20:35], v[160:163], v[136:139], v[20:35]
    s_waitcnt lgkmcnt(11)
    v_mfma_f32_32x32x16_bf16 v[36:51], v[164:167], v[136:139], v[36:51]
    s_waitcnt lgkmcnt(9)
    v_mfma_f32_32x32x16_bf16 v[52:67], v[136:139], v[168:171], v[52:67]
    s_waitcnt lgkmcnt(8)
    s_cbranch_vccnz gated_mix__sliding_local_dilated__grouped_kv_mqa__prompt_kernel_hv2
    v_mfma_f32_32x32x16_bf16 v[68:83], v[164:167], v[144:147], v[68:83]
    s_branch gated_mix__sliding_local_dilated__grouped_kv_mqa__prompt_kernel_hd2
gated_mix__sliding_local_dilated__grouped_kv_mqa__prompt_kernel_hv2:
    v_mfma_f32_32x32x16_bf16 v[68:83], v[144:147], v[168:171], v[68:83]
gated_mix__sliding_local_dilated__grouped_kv_mqa__prompt_kernel_hd2:
    ds_read_b128 v[136:139], v176 offset:0
    ds_read_b64_tr_b16 v[160:161], v172 offset:6144
    ds_read_b64_tr_b16 v[162:163], v172 offset:6656
    ds_read_b64_tr_b16 v[164:165], v172 offset:14336
    ds_read_b64_tr_b16 v[166:167], v172 offset:14848
    ds_read_b64_tr_b16 v[168:169], v172 offset:22528
    ds_read_b64_tr_b16 v[170:171], v172 offset:23040
    ds_read_b128 v[144:147], v180 offset:0
    s_waitcnt lgkmcnt(13)
    v_mfma_f32_32x32x16_bf16 v[20:35], v[148:151], v[132:135], v[20:35]
    s_waitcnt lgkmcnt(11)
    v_mfma_f32_32x32x16_bf16 v[36:51], v[152:155], v[132:135], v[36:51]
    s_waitcnt lgkmcnt(9)
    v_mfma_f32_32x32x16_bf16 v[52:67], v[132:135], v[156:159], v[52:67]
    s_waitcnt lgkmcnt(8)
    s_cbranch_vccnz gated_mix__sliding_local_dilated__grouped_kv_mqa__prompt_kernel_hv3
    v_mfma_f32_32x32x16_bf16 v[68:83], v[152:155], v[140:143], v[68:83]
    s_branch gated_mix__sliding_local_dilated__grouped_kv_mqa__prompt_kernel_hd3
gated_mix__sliding_local_dilated__grouped_kv_mqa__prompt_kernel_hv3:
    v_mfma_f32_32x32x16_bf16 v[68:83], v[140:143], v[156:159], v[68:83]
gated_mix__sliding_local_dilated__grouped_kv_mqa__prompt_kernel_hd3:
    s_waitcnt lgkmcnt(5)
    v_mfma_f32_32x32x16_bf16 v[20:35], v[160:163], v[136:139], v[20:35]
    s_waitcnt lgkmcnt(3)
    v_mfma_f32_32x32x16_bf16 v[36:51], v[164:167], v[136:139], v[36:51]
    s_waitcnt lgkmcnt(1)
    v_mfma_f32_32x32x16_bf16 v[52:67], v[136:139], v[168:171], v[52:67]
    s_waitcnt lgkmcnt(0)
    s_cbranch_vccnz gated_mix__sliding_local_dilated__grouped_kv_mqa__prompt_kernel_hv4
    v_mfma_f32_32x32x16_bf16 v[68:83], v[164:167], v[144:147], v[68:83]
    s_branch gated_mix__sliding_local_dilated__grouped_kv_mqa__prompt_kernel_hd4
gated_mix__sliding_local_dilated__grouped_kv_mqa__prompt_kernel_hv4:
    v_mfma_f32_32x32x16_bf16 v[68:83], v[144:147], v[168:171], v[68:83]
gated_mix__sliding_local_dilated__grouped_kv_mqa__prompt_kernel_hd4:
    s_waitcnt vmcnt(2)
    s_waitcnt lgkmcnt(0)
    s_barrier
    s_add_u32 m0, s83, 155648
    s_add_u32 s5, s83, 57344
    buffer_load_dwordx4 v4, s[24:27], s5 offen lds
    s_add_u32 m0, s83, 159744
    s_add_u32 s5, s83, 61440
    buffer_load_dwordx4 v4, s[24:27], s5 offen lds
    s_add_u32 s6, s74, 2
    s_and_b32 s6, s6, 7
    s_mul_i32 s7, s6, 196608
    s_add_u32 m0, s84, 81920
    s_add_u32 s5, s7, 0
    buffer_load_dwordx4 v128, s[28:31], s5 offen lds
    s_add_u32 m0, s84, 82944
    s_add_u32 s5, s7, 24576
    buffer_load_dwordx4 v128, s[28:31], s5 offen lds
    s_add_u32 m0, s84, 90112
    s_add_u32 s5, s7, 1024
    buffer_load_dwordx4 v128, s[28:31], s5 offen lds
    s_add_u32 m0, s84, 91136
    s_add_u32 s5, s7, 25600
    buffer_load_dwordx4 v128, s[28:31], s5 offen lds
    s_add_u32 m0, s84, 98304
    s_add_u32 s5, s7, 2048
    buffer_load_dwordx4 v128, s[28:31], s5 offen lds
    s_add_u32 m0, s84, 99328
    s_add_u32 s5, s7, 26624
    buffer_load_dwordx4 v128, s[28:31], s5 offen lds
    s_mov_b64 vcc, s[70:71]
    ds_read_b128 v[132:135], v173 offset:8192
    ds_read_b64_tr_b16 v[148:149], v172 offset:24576
    ds_read_b64_tr_b16 v[150:151], v172 offset:25088
    ds_read_b64_tr_b16 v[152:153], v172 offset:32768
    ds_read_b64_tr_b16 v[154:155], v172 offset:33280
    ds_read_b64_tr_b16 v[156:157], v172 offset:40960
    ds_read_b64_tr_b16 v[158:159], v172 offset:41472
    ds_read_b128 v[140:143], v177 offset:2048
    ds_read_b128 v[136:139], v174 offset:8192
    ds_read_b64_tr_b16 v[160:161], v172 offset:26624
    ds_read_b64_tr_b16 v[162:163], v172 offset:27136
    ds_read_b64_tr_b16 v[164:165], v172 offset:34816
    ds_read_b64_tr_b16 v[166:167], v172 offset:35328
    ds_read_b64_tr_b16 v[168:169], v172 offset:43008
    ds_read_b64_tr_b16 v[170:171], v172 offset:43520
    ds_read_b128 v[144:147], v178 offset:2048
    s_waitcnt lgkmcnt(13)
    v_mfma_f32_32x32x16_bf16 v[20:35], v[148:151], v[132:135], v[20:35]
    s_waitcnt lgkmcnt(11)
    v_mfma_f32_32x32x16_bf16 v[36:51], v[152:155], v[132:135], v[36:51]
    s_waitcnt lgkmcnt(9)
    v_mfma_f32_32x32x16_bf16 v[52:67], v[132:135], v[156:159], v[52:67]
    s_waitcnt lgkmcnt(8)
    s_cbranch_vccnz gated_mix__sliding_local_dilated__grouped_kv_mqa__prompt_kernel_hv5
    v_mfma_f32_32x32x16_bf16 v[68:83], v[152:155], v[140:143], v[68:83]
    s_branch gated_mix__sliding_local_dilated__grouped_kv_mqa__prompt_kernel_hd5
gated_mix__sliding_local_dilated__grouped_kv_mqa__prompt_kernel_hv5:
    v_mfma_f32_32x32x16_bf16 v[68:83], v[140:143], v[156:159], v[68:83]
gated_mix__sliding_local_dilated__grouped_kv_mqa__prompt_kernel_hd5:
    ds_read_b128 v[132:135], v175 offset:8192
    ds_read_b64_tr_b16 v[148:149], v172 offset:28672
    ds_read_b64_tr_b16 v[150:151], v172 offset:29184
    ds_read_b64_tr_b16 v[152:153], v172 offset:36864
    ds_read_b64_tr_b16 v[154:155], v172 offset:37376
    ds_read_b64_tr_b16 v[156:157], v172 offset:45056
    ds_read_b64_tr_b16 v[158:159], v172 offset:45568
    ds_read_b128 v[140:143], v179 offset:2048
    s_waitcnt lgkmcnt(13)
    v_mfma_f32_32x32x16_bf16 v[20:35], v[160:163], v[136:139], v[20:35]
    s_waitcnt lgkmcnt(11)
    v_mfma_f32_32x32x16_bf16 v[36:51], v[164:167], v[136:139], v[36:51]
    s_waitcnt lgkmcnt(9)
    v_mfma_f32_32x32x16_bf16 v[52:67], v[136:139], v[168:171], v[52:67]
    s_waitcnt lgkmcnt(8)
    s_cbranch_vccnz gated_mix__sliding_local_dilated__grouped_kv_mqa__prompt_kernel_hv6
    v_mfma_f32_32x32x16_bf16 v[68:83], v[164:167], v[144:147], v[68:83]
    s_branch gated_mix__sliding_local_dilated__grouped_kv_mqa__prompt_kernel_hd6
gated_mix__sliding_local_dilated__grouped_kv_mqa__prompt_kernel_hv6:
    v_mfma_f32_32x32x16_bf16 v[68:83], v[144:147], v[168:171], v[68:83]
gated_mix__sliding_local_dilated__grouped_kv_mqa__prompt_kernel_hd6:
    ds_read_b128 v[136:139], v176 offset:8192
    ds_read_b64_tr_b16 v[160:161], v172 offset:30720
    ds_read_b64_tr_b16 v[162:163], v172 offset:31232
    ds_read_b64_tr_b16 v[164:165], v172 offset:38912
    ds_read_b64_tr_b16 v[166:167], v172 offset:39424
    ds_read_b64_tr_b16 v[168:169], v172 offset:47104
    ds_read_b64_tr_b16 v[170:171], v172 offset:47616
    ds_read_b128 v[144:147], v180 offset:2048
    s_waitcnt lgkmcnt(13)
    v_mfma_f32_32x32x16_bf16 v[20:35], v[148:151], v[132:135], v[20:35]
    s_waitcnt lgkmcnt(11)
    v_mfma_f32_32x32x16_bf16 v[36:51], v[152:155], v[132:135], v[36:51]
    s_waitcnt lgkmcnt(9)
    v_mfma_f32_32x32x16_bf16 v[52:67], v[132:135], v[156:159], v[52:67]
    s_waitcnt lgkmcnt(8)
    s_cbranch_vccnz gated_mix__sliding_local_dilated__grouped_kv_mqa__prompt_kernel_hv7
    v_mfma_f32_32x32x16_bf16 v[68:83], v[152:155], v[140:143], v[68:83]
    s_branch gated_mix__sliding_local_dilated__grouped_kv_mqa__prompt_kernel_hd7
gated_mix__sliding_local_dilated__grouped_kv_mqa__prompt_kernel_hv7:
    v_mfma_f32_32x32x16_bf16 v[68:83], v[140:143], v[156:159], v[68:83]
gated_mix__sliding_local_dilated__grouped_kv_mqa__prompt_kernel_hd7:
    s_waitcnt lgkmcnt(5)
    v_mfma_f32_32x32x16_bf16 v[20:35], v[160:163], v[136:139], v[20:35]
    s_waitcnt lgkmcnt(3)
    v_mfma_f32_32x32x16_bf16 v[36:51], v[164:167], v[136:139], v[36:51]
    s_waitcnt lgkmcnt(1)
    v_mfma_f32_32x32x16_bf16 v[52:67], v[136:139], v[168:171], v[52:67]
    s_waitcnt lgkmcnt(0)
    s_cbranch_vccnz gated_mix__sliding_local_dilated__grouped_kv_mqa__prompt_kernel_hv8
    v_mfma_f32_32x32x16_bf16 v[68:83], v[164:167], v[144:147], v[68:83]
    s_branch gated_mix__sliding_local_dilated__grouped_kv_mqa__prompt_kernel_hd8
gated_mix__sliding_local_dilated__grouped_kv_mqa__prompt_kernel_hv8:
    v_mfma_f32_32x32x16_bf16 v[68:83], v[144:147], v[168:171], v[68:83]
gated_mix__sliding_local_dilated__grouped_kv_mqa__prompt_kernel_hd8:
    s_waitcnt vmcnt(0)
    s_waitcnt lgkmcnt(0)
    s_barrier
    s_add_u32 m0, s83, 131072
    s_add_u32 s5, s83, 65536
    buffer_load_dwordx4 v4, s[24:27], s5 offen lds
    s_add_u32 m0, s83, 135168
    s_add_u32 s5, s83, 69632
    buffer_load_dwordx4 v4, s[24:27], s5 offen lds
    s_add_u32 s6, s74, 3
    s_and_b32 s6, s6, 7
    s_mul_i32 s7, s6, 196608
    s_add_u32 m0, s84, 106496
    s_add_u32 s5, s7, 0
    buffer_load_dwordx4 v128, s[28:31], s5 offen lds
    s_add_u32 m0, s84, 107520
    s_add_u32 s5, s7, 24576
    buffer_load_dwordx4 v128, s[28:31], s5 offen lds
    s_add_u32 m0, s84, 114688
    s_add_u32 s5, s7, 1024
    buffer_load_dwordx4 v128, s[28:31], s5 offen lds
    s_add_u32 m0, s84, 115712
    s_add_u32 s5, s7, 25600
    buffer_load_dwordx4 v128, s[28:31], s5 offen lds
    s_add_u32 m0, s84, 122880
    s_add_u32 s5, s7, 2048
    buffer_load_dwordx4 v128, s[28:31], s5 offen lds
    s_add_u32 m0, s84, 123904
    s_add_u32 s5, s7, 26624
    buffer_load_dwordx4 v128, s[28:31], s5 offen lds
    s_mov_b64 vcc, s[70:71]
    ds_read_b128 v[132:135], v173 offset:16384
    ds_read_b64_tr_b16 v[148:149], v172 offset:0
    ds_read_b64_tr_b16 v[150:151], v172 offset:512
    ds_read_b64_tr_b16 v[152:153], v172 offset:8192
    ds_read_b64_tr_b16 v[154:155], v172 offset:8704
    ds_read_b64_tr_b16 v[156:157], v172 offset:16384
    ds_read_b64_tr_b16 v[158:159], v172 offset:16896
    ds_read_b128 v[140:143], v177 offset:4096
    ds_read_b128 v[136:139], v174 offset:16384
    ds_read_b64_tr_b16 v[160:161], v172 offset:2048
    ds_read_b64_tr_b16 v[162:163], v172 offset:2560
    ds_read_b64_tr_b16 v[164:165], v172 offset:10240
    ds_read_b64_tr_b16 v[166:167], v172 offset:10752
    ds_read_b64_tr_b16 v[168:169], v172 offset:18432
    ds_read_b64_tr_b16 v[170:171], v172 offset:18944
    ds_read_b128 v[144:147], v178 offset:4096
    s_waitcnt lgkmcnt(13)
    v_mfma_f32_32x32x16_bf16 v[20:35], v[148:151], v[132:135], v[20:35]
    s_waitcnt lgkmcnt(11)
    v_mfma_f32_32x32x16_bf16 v[36:51], v[152:155], v[132:135], v[36:51]
    s_waitcnt lgkmcnt(9)
    v_mfma_f32_32x32x16_bf16 v[52:67], v[132:135], v[156:159], v[52:67]
    s_waitcnt lgkmcnt(8)
    s_cbranch_vccnz gated_mix__sliding_local_dilated__grouped_kv_mqa__prompt_kernel_hv9
    v_mfma_f32_32x32x16_bf16 v[68:83], v[152:155], v[140:143], v[68:83]
    s_branch gated_mix__sliding_local_dilated__grouped_kv_mqa__prompt_kernel_hd9
gated_mix__sliding_local_dilated__grouped_kv_mqa__prompt_kernel_hv9:
    v_mfma_f32_32x32x16_bf16 v[68:83], v[140:143], v[156:159], v[68:83]
gated_mix__sliding_local_dilated__grouped_kv_mqa__prompt_kernel_hd9:
    ds_read_b128 v[132:135], v175 offset:16384
    ds_read_b64_tr_b16 v[148:149], v172 offset:4096
    ds_read_b64_tr_b16 v[150:151], v172 offset:4608
    ds_read_b64_tr_b16 v[152:153], v172 offset:12288
    ds_read_b64_tr_b16 v[154:155], v172 offset:12800
    ds_read_b64_tr_b16 v[156:157], v172 offset:20480
    ds_read_b64_tr_b16 v[158:159], v172 offset:20992
    ds_read_b128 v[140:143], v179 offset:4096
    s_waitcnt lgkmcnt(13)
    v_mfma_f32_32x32x16_bf16 v[20:35], v[160:163], v[136:139], v[20:35]
    s_waitcnt lgkmcnt(11)
    v_mfma_f32_32x32x16_bf16 v[36:51], v[164:167], v[136:139], v[36:51]
    s_waitcnt lgkmcnt(9)
    v_mfma_f32_32x32x16_bf16 v[52:67], v[136:139], v[168:171], v[52:67]
    s_waitcnt lgkmcnt(8)
    s_cbranch_vccnz gated_mix__sliding_local_dilated__grouped_kv_mqa__prompt_kernel_hv10
    v_mfma_f32_32x32x16_bf16 v[68:83], v[164:167], v[144:147], v[68:83]
    s_branch gated_mix__sliding_local_dilated__grouped_kv_mqa__prompt_kernel_hd10
gated_mix__sliding_local_dilated__grouped_kv_mqa__prompt_kernel_hv10:
    v_mfma_f32_32x32x16_bf16 v[68:83], v[144:147], v[168:171], v[68:83]
gated_mix__sliding_local_dilated__grouped_kv_mqa__prompt_kernel_hd10:
    ds_read_b128 v[136:139], v176 offset:16384
    ds_read_b64_tr_b16 v[160:161], v172 offset:6144
    ds_read_b64_tr_b16 v[162:163], v172 offset:6656
    ds_read_b64_tr_b16 v[164:165], v172 offset:14336
    ds_read_b64_tr_b16 v[166:167], v172 offset:14848
    ds_read_b64_tr_b16 v[168:169], v172 offset:22528
    ds_read_b64_tr_b16 v[170:171], v172 offset:23040
    ds_read_b128 v[144:147], v180 offset:4096
    s_waitcnt lgkmcnt(13)
    v_mfma_f32_32x32x16_bf16 v[20:35], v[148:151], v[132:135], v[20:35]
    s_waitcnt lgkmcnt(11)
    v_mfma_f32_32x32x16_bf16 v[36:51], v[152:155], v[132:135], v[36:51]
    s_waitcnt lgkmcnt(9)
    v_mfma_f32_32x32x16_bf16 v[52:67], v[132:135], v[156:159], v[52:67]
    s_waitcnt lgkmcnt(8)
    s_cbranch_vccnz gated_mix__sliding_local_dilated__grouped_kv_mqa__prompt_kernel_hv11
    v_mfma_f32_32x32x16_bf16 v[68:83], v[152:155], v[140:143], v[68:83]
    s_branch gated_mix__sliding_local_dilated__grouped_kv_mqa__prompt_kernel_hd11
gated_mix__sliding_local_dilated__grouped_kv_mqa__prompt_kernel_hv11:
    v_mfma_f32_32x32x16_bf16 v[68:83], v[140:143], v[156:159], v[68:83]
gated_mix__sliding_local_dilated__grouped_kv_mqa__prompt_kernel_hd11:
    s_waitcnt lgkmcnt(5)
    v_mfma_f32_32x32x16_bf16 v[20:35], v[160:163], v[136:139], v[20:35]
    s_waitcnt lgkmcnt(3)
    v_mfma_f32_32x32x16_bf16 v[36:51], v[164:167], v[136:139], v[36:51]
    s_waitcnt lgkmcnt(1)
    v_mfma_f32_32x32x16_bf16 v[52:67], v[136:139], v[168:171], v[52:67]
    s_waitcnt lgkmcnt(0)
    s_cbranch_vccnz gated_mix__sliding_local_dilated__grouped_kv_mqa__prompt_kernel_hv12
    v_mfma_f32_32x32x16_bf16 v[68:83], v[164:167], v[144:147], v[68:83]
    s_branch gated_mix__sliding_local_dilated__grouped_kv_mqa__prompt_kernel_hd12
gated_mix__sliding_local_dilated__grouped_kv_mqa__prompt_kernel_hv12:
    v_mfma_f32_32x32x16_bf16 v[68:83], v[144:147], v[168:171], v[68:83]
gated_mix__sliding_local_dilated__grouped_kv_mqa__prompt_kernel_hd12:
    s_waitcnt vmcnt(0)
    s_waitcnt lgkmcnt(0)
    s_barrier
    s_add_u32 m0, s83, 139264
    s_add_u32 s5, s83, 73728
    buffer_load_dwordx4 v4, s[24:27], s5 offen lds
    s_add_u32 m0, s83, 143360
    s_add_u32 s5, s83, 77824
    buffer_load_dwordx4 v4, s[24:27], s5 offen lds
    s_add_u32 s6, s74, 4
    s_and_b32 s6, s6, 7
    s_mul_i32 s7, s6, 196608
    s_add_u32 m0, s84, 81920
    s_add_u32 s5, s7, 0
    buffer_load_dwordx4 v128, s[28:31], s5 offen lds
    s_add_u32 m0, s84, 82944
    s_add_u32 s5, s7, 24576
    buffer_load_dwordx4 v128, s[28:31], s5 offen lds
    s_add_u32 m0, s84, 90112
    s_add_u32 s5, s7, 1024
    buffer_load_dwordx4 v128, s[28:31], s5 offen lds
    s_add_u32 m0, s84, 91136
    s_add_u32 s5, s7, 25600
    buffer_load_dwordx4 v128, s[28:31], s5 offen lds
    s_add_u32 m0, s84, 98304
    s_add_u32 s5, s7, 2048
    buffer_load_dwordx4 v128, s[28:31], s5 offen lds
    s_add_u32 m0, s84, 99328
    s_add_u32 s5, s7, 26624
    buffer_load_dwordx4 v128, s[28:31], s5 offen lds
    s_mov_b64 vcc, s[70:71]
    ds_read_b128 v[132:135], v173 offset:24576
    ds_read_b64_tr_b16 v[148:149], v172 offset:24576
    ds_read_b64_tr_b16 v[150:151], v172 offset:25088
    ds_read_b64_tr_b16 v[152:153], v172 offset:32768
    ds_read_b64_tr_b16 v[154:155], v172 offset:33280
    ds_read_b64_tr_b16 v[156:157], v172 offset:40960
    ds_read_b64_tr_b16 v[158:159], v172 offset:41472
    ds_read_b128 v[140:143], v177 offset:6144
    ds_read_b128 v[136:139], v174 offset:24576
    ds_read_b64_tr_b16 v[160:161], v172 offset:26624
    ds_read_b64_tr_b16 v[162:163], v172 offset:27136
    ds_read_b64_tr_b16 v[164:165], v172 offset:34816
    ds_read_b64_tr_b16 v[166:167], v172 offset:35328
    ds_read_b64_tr_b16 v[168:169], v172 offset:43008
    ds_read_b64_tr_b16 v[170:171], v172 offset:43520
    ds_read_b128 v[144:147], v178 offset:6144
    s_waitcnt lgkmcnt(13)
    v_mfma_f32_32x32x16_bf16 v[20:35], v[148:151], v[132:135], v[20:35]
    s_waitcnt lgkmcnt(11)
    v_mfma_f32_32x32x16_bf16 v[36:51], v[152:155], v[132:135], v[36:51]
    s_waitcnt lgkmcnt(9)
    v_mfma_f32_32x32x16_bf16 v[52:67], v[132:135], v[156:159], v[52:67]
    s_waitcnt lgkmcnt(8)
    s_cbranch_vccnz gated_mix__sliding_local_dilated__grouped_kv_mqa__prompt_kernel_hv13
    v_mfma_f32_32x32x16_bf16 v[68:83], v[152:155], v[140:143], v[68:83]
    s_branch gated_mix__sliding_local_dilated__grouped_kv_mqa__prompt_kernel_hd13
gated_mix__sliding_local_dilated__grouped_kv_mqa__prompt_kernel_hv13:
    v_mfma_f32_32x32x16_bf16 v[68:83], v[140:143], v[156:159], v[68:83]
gated_mix__sliding_local_dilated__grouped_kv_mqa__prompt_kernel_hd13:
    ds_read_b128 v[132:135], v175 offset:24576
    ds_read_b64_tr_b16 v[148:149], v172 offset:28672
    ds_read_b64_tr_b16 v[150:151], v172 offset:29184
    ds_read_b64_tr_b16 v[152:153], v172 offset:36864
    ds_read_b64_tr_b16 v[154:155], v172 offset:37376
    ds_read_b64_tr_b16 v[156:157], v172 offset:45056
    ds_read_b64_tr_b16 v[158:159], v172 offset:45568
    ds_read_b128 v[140:143], v179 offset:6144
    s_waitcnt lgkmcnt(13)
    v_mfma_f32_32x32x16_bf16 v[20:35], v[160:163], v[136:139], v[20:35]
    s_waitcnt lgkmcnt(11)
    v_mfma_f32_32x32x16_bf16 v[36:51], v[164:167], v[136:139], v[36:51]
    s_waitcnt lgkmcnt(9)
    v_mfma_f32_32x32x16_bf16 v[52:67], v[136:139], v[168:171], v[52:67]
    s_waitcnt lgkmcnt(8)
    s_cbranch_vccnz gated_mix__sliding_local_dilated__grouped_kv_mqa__prompt_kernel_hv14
    v_mfma_f32_32x32x16_bf16 v[68:83], v[164:167], v[144:147], v[68:83]
    s_branch gated_mix__sliding_local_dilated__grouped_kv_mqa__prompt_kernel_hd14
gated_mix__sliding_local_dilated__grouped_kv_mqa__prompt_kernel_hv14:
    v_mfma_f32_32x32x16_bf16 v[68:83], v[144:147], v[168:171], v[68:83]
gated_mix__sliding_local_dilated__grouped_kv_mqa__prompt_kernel_hd14:
    ds_read_b128 v[136:139], v176 offset:24576
    ds_read_b64_tr_b16 v[160:161], v172 offset:30720
    ds_read_b64_tr_b16 v[162:163], v172 offset:31232
    ds_read_b64_tr_b16 v[164:165], v172 offset:38912
    ds_read_b64_tr_b16 v[166:167], v172 offset:39424
    ds_read_b64_tr_b16 v[168:169], v172 offset:47104
    ds_read_b64_tr_b16 v[170:171], v172 offset:47616
    ds_read_b128 v[144:147], v180 offset:6144
    s_waitcnt lgkmcnt(13)
    v_mfma_f32_32x32x16_bf16 v[20:35], v[148:151], v[132:135], v[20:35]
    s_waitcnt lgkmcnt(11)
    v_mfma_f32_32x32x16_bf16 v[36:51], v[152:155], v[132:135], v[36:51]
    s_waitcnt lgkmcnt(9)
    v_mfma_f32_32x32x16_bf16 v[52:67], v[132:135], v[156:159], v[52:67]
    s_waitcnt lgkmcnt(8)
    s_cbranch_vccnz gated_mix__sliding_local_dilated__grouped_kv_mqa__prompt_kernel_hv15
    v_mfma_f32_32x32x16_bf16 v[68:83], v[152:155], v[140:143], v[68:83]
    s_branch gated_mix__sliding_local_dilated__grouped_kv_mqa__prompt_kernel_hd15
gated_mix__sliding_local_dilated__grouped_kv_mqa__prompt_kernel_hv15:
    v_mfma_f32_32x32x16_bf16 v[68:83], v[140:143], v[156:159], v[68:83]
gated_mix__sliding_local_dilated__grouped_kv_mqa__prompt_kernel_hd15:
    s_waitcnt lgkmcnt(5)
    v_mfma_f32_32x32x16_bf16 v[20:35], v[160:163], v[136:139], v[20:35]
    s_waitcnt lgkmcnt(3)
    v_mfma_f32_32x32x16_bf16 v[36:51], v[164:167], v[136:139], v[36:51]
    s_waitcnt lgkmcnt(1)
    v_mfma_f32_32x32x16_bf16 v[52:67], v[136:139], v[168:171], v[52:67]
    s_waitcnt lgkmcnt(0)
    s_cbranch_vccnz gated_mix__sliding_local_dilated__grouped_kv_mqa__prompt_kernel_hv16
    v_mfma_f32_32x32x16_bf16 v[68:83], v[164:167], v[144:147], v[68:83]
    s_branch gated_mix__sliding_local_dilated__grouped_kv_mqa__prompt_kernel_hd16
gated_mix__sliding_local_dilated__grouped_kv_mqa__prompt_kernel_hv16:
    v_mfma_f32_32x32x16_bf16 v[68:83], v[144:147], v[168:171], v[68:83]
gated_mix__sliding_local_dilated__grouped_kv_mqa__prompt_kernel_hd16:
    s_waitcnt vmcnt(0)
    s_waitcnt lgkmcnt(0)
    s_barrier
    s_add_u32 m0, s83, 147456
    s_add_u32 s5, s83, 81920
    buffer_load_dwordx4 v4, s[24:27], s5 offen lds
    s_add_u32 m0, s83, 151552
    s_add_u32 s5, s83, 86016
    buffer_load_dwordx4 v4, s[24:27], s5 offen lds
    s_add_u32 s6, s74, 5
    s_and_b32 s6, s6, 7
    s_mul_i32 s7, s6, 196608
    s_add_u32 m0, s84, 106496
    s_add_u32 s5, s7, 0
    buffer_load_dwordx4 v128, s[28:31], s5 offen lds
    s_add_u32 m0, s84, 107520
    s_add_u32 s5, s7, 24576
    buffer_load_dwordx4 v128, s[28:31], s5 offen lds
    s_add_u32 m0, s84, 114688
    s_add_u32 s5, s7, 1024
    buffer_load_dwordx4 v128, s[28:31], s5 offen lds
    s_add_u32 m0, s84, 115712
    s_add_u32 s5, s7, 25600
    buffer_load_dwordx4 v128, s[28:31], s5 offen lds
    s_add_u32 m0, s84, 122880
    s_add_u32 s5, s7, 2048
    buffer_load_dwordx4 v128, s[28:31], s5 offen lds
    s_add_u32 m0, s84, 123904
    s_add_u32 s5, s7, 26624
    buffer_load_dwordx4 v128, s[28:31], s5 offen lds
    s_mov_b64 vcc, s[70:71]
    ds_read_b128 v[132:135], v173 offset:32768
    ds_read_b64_tr_b16 v[148:149], v172 offset:0
    ds_read_b64_tr_b16 v[150:151], v172 offset:512
    ds_read_b64_tr_b16 v[152:153], v172 offset:8192
    ds_read_b64_tr_b16 v[154:155], v172 offset:8704
    ds_read_b64_tr_b16 v[156:157], v172 offset:16384
    ds_read_b64_tr_b16 v[158:159], v172 offset:16896
    ds_read_b128 v[140:143], v177 offset:8192
    ds_read_b128 v[136:139], v174 offset:32768
    ds_read_b64_tr_b16 v[160:161], v172 offset:2048
    ds_read_b64_tr_b16 v[162:163], v172 offset:2560
    ds_read_b64_tr_b16 v[164:165], v172 offset:10240
    ds_read_b64_tr_b16 v[166:167], v172 offset:10752
    ds_read_b64_tr_b16 v[168:169], v172 offset:18432
    ds_read_b64_tr_b16 v[170:171], v172 offset:18944
    ds_read_b128 v[144:147], v178 offset:8192
    s_waitcnt lgkmcnt(13)
    v_mfma_f32_32x32x16_bf16 v[20:35], v[148:151], v[132:135], v[20:35]
    s_waitcnt lgkmcnt(11)
    v_mfma_f32_32x32x16_bf16 v[36:51], v[152:155], v[132:135], v[36:51]
    s_waitcnt lgkmcnt(9)
    v_mfma_f32_32x32x16_bf16 v[52:67], v[132:135], v[156:159], v[52:67]
    s_waitcnt lgkmcnt(8)
    s_cbranch_vccnz gated_mix__sliding_local_dilated__grouped_kv_mqa__prompt_kernel_hv17
    v_mfma_f32_32x32x16_bf16 v[68:83], v[152:155], v[140:143], v[68:83]
    s_branch gated_mix__sliding_local_dilated__grouped_kv_mqa__prompt_kernel_hd17
gated_mix__sliding_local_dilated__grouped_kv_mqa__prompt_kernel_hv17:
    v_mfma_f32_32x32x16_bf16 v[68:83], v[140:143], v[156:159], v[68:83]
gated_mix__sliding_local_dilated__grouped_kv_mqa__prompt_kernel_hd17:
    ds_read_b128 v[132:135], v175 offset:32768
    ds_read_b64_tr_b16 v[148:149], v172 offset:4096
    ds_read_b64_tr_b16 v[150:151], v172 offset:4608
    ds_read_b64_tr_b16 v[152:153], v172 offset:12288
    ds_read_b64_tr_b16 v[154:155], v172 offset:12800
    ds_read_b64_tr_b16 v[156:157], v172 offset:20480
    ds_read_b64_tr_b16 v[158:159], v172 offset:20992
    ds_read_b128 v[140:143], v179 offset:8192
    s_waitcnt lgkmcnt(13)
    v_mfma_f32_32x32x16_bf16 v[20:35], v[160:163], v[136:139], v[20:35]
    s_waitcnt lgkmcnt(11)
    v_mfma_f32_32x32x16_bf16 v[36:51], v[164:167], v[136:139], v[36:51]
    s_waitcnt lgkmcnt(9)
    v_mfma_f32_32x32x16_bf16 v[52:67], v[136:139], v[168:171], v[52:67]
    s_waitcnt lgkmcnt(8)
    s_cbranch_vccnz gated_mix__sliding_local_dilated__grouped_kv_mqa__prompt_kernel_hv18
    v_mfma_f32_32x32x16_bf16 v[68:83], v[164:167], v[144:147], v[68:83]
    s_branch gated_mix__sliding_local_dilated__grouped_kv_mqa__prompt_kernel_hd18
gated_mix__sliding_local_dilated__grouped_kv_mqa__prompt_kernel_hv18:
    v_mfma_f32_32x32x16_bf16 v[68:83], v[144:147], v[168:171], v[68:83]
gated_mix__sliding_local_dilated__grouped_kv_mqa__prompt_kernel_hd18:
    ds_read_b128 v[136:139], v176 offset:32768
    ds_read_b64_tr_b16 v[160:161], v172 offset:6144
    ds_read_b64_tr_b16 v[162:163], v172 offset:6656
    ds_read_b64_tr_b16 v[164:165], v172 offset:14336
    ds_read_b64_tr_b16 v[166:167], v172 offset:14848
    ds_read_b64_tr_b16 v[168:169], v172 offset:22528
    ds_read_b64_tr_b16 v[170:171], v172 offset:23040
    ds_read_b128 v[144:147], v180 offset:8192
    s_waitcnt lgkmcnt(13)
    v_mfma_f32_32x32x16_bf16 v[20:35], v[148:151], v[132:135], v[20:35]
    s_waitcnt lgkmcnt(11)
    v_mfma_f32_32x32x16_bf16 v[36:51], v[152:155], v[132:135], v[36:51]
    s_waitcnt lgkmcnt(9)
    v_mfma_f32_32x32x16_bf16 v[52:67], v[132:135], v[156:159], v[52:67]
    s_waitcnt lgkmcnt(8)
    s_cbranch_vccnz gated_mix__sliding_local_dilated__grouped_kv_mqa__prompt_kernel_hv19
    v_mfma_f32_32x32x16_bf16 v[68:83], v[152:155], v[140:143], v[68:83]
    s_branch gated_mix__sliding_local_dilated__grouped_kv_mqa__prompt_kernel_hd19
gated_mix__sliding_local_dilated__grouped_kv_mqa__prompt_kernel_hv19:
    v_mfma_f32_32x32x16_bf16 v[68:83], v[140:143], v[156:159], v[68:83]
gated_mix__sliding_local_dilated__grouped_kv_mqa__prompt_kernel_hd19:
    s_waitcnt lgkmcnt(5)
    v_mfma_f32_32x32x16_bf16 v[20:35], v[160:163], v[136:139], v[20:35]
    s_waitcnt lgkmcnt(3)
    v_mfma_f32_32x32x16_bf16 v[36:51], v[164:167], v[136:139], v[36:51]
    s_waitcnt lgkmcnt(1)
    v_mfma_f32_32x32x16_bf16 v[52:67], v[136:139], v[168:171], v[52:67]
    s_waitcnt lgkmcnt(0)
    s_cbranch_vccnz gated_mix__sliding_local_dilated__grouped_kv_mqa__prompt_kernel_hv20
    v_mfma_f32_32x32x16_bf16 v[68:83], v[164:167], v[144:147], v[68:83]
    s_branch gated_mix__sliding_local_dilated__grouped_kv_mqa__prompt_kernel_hd20
gated_mix__sliding_local_dilated__grouped_kv_mqa__prompt_kernel_hv20:
    v_mfma_f32_32x32x16_bf16 v[68:83], v[144:147], v[168:171], v[68:83]
gated_mix__sliding_local_dilated__grouped_kv_mqa__prompt_kernel_hd20:
    s_waitcnt vmcnt(0)
    s_waitcnt lgkmcnt(0)
    s_barrier
    s_add_u32 m0, s83, 155648
    s_add_u32 s5, s83, 90112
    buffer_load_dwordx4 v4, s[24:27], s5 offen lds
    s_add_u32 m0, s83, 159744
    s_add_u32 s5, s83, 94208
    buffer_load_dwordx4 v4, s[24:27], s5 offen lds
    s_add_u32 s6, s74, 6
    s_and_b32 s6, s6, 7
    s_mul_i32 s7, s6, 196608
    s_add_u32 m0, s84, 81920
    s_add_u32 s5, s7, 0
    buffer_load_dwordx4 v128, s[28:31], s5 offen lds
    s_add_u32 m0, s84, 82944
    s_add_u32 s5, s7, 24576
    buffer_load_dwordx4 v128, s[28:31], s5 offen lds
    s_add_u32 m0, s84, 90112
    s_add_u32 s5, s7, 1024
    buffer_load_dwordx4 v128, s[28:31], s5 offen lds
    s_add_u32 m0, s84, 91136
    s_add_u32 s5, s7, 25600
    buffer_load_dwordx4 v128, s[28:31], s5 offen lds
    s_add_u32 m0, s84, 98304
    s_add_u32 s5, s7, 2048
    buffer_load_dwordx4 v128, s[28:31], s5 offen lds
    s_add_u32 m0, s84, 99328
    s_add_u32 s5, s7, 26624
    buffer_load_dwordx4 v128, s[28:31], s5 offen lds
    s_mov_b64 vcc, s[70:71]
    ds_read_b128 v[132:135], v173 offset:40960
    ds_read_b64_tr_b16 v[148:149], v172 offset:24576
    ds_read_b64_tr_b16 v[150:151], v172 offset:25088
    ds_read_b64_tr_b16 v[152:153], v172 offset:32768
    ds_read_b64_tr_b16 v[154:155], v172 offset:33280
    ds_read_b64_tr_b16 v[156:157], v172 offset:40960
    ds_read_b64_tr_b16 v[158:159], v172 offset:41472
    ds_read_b128 v[140:143], v177 offset:10240
    ds_read_b128 v[136:139], v174 offset:40960
    ds_read_b64_tr_b16 v[160:161], v172 offset:26624
    ds_read_b64_tr_b16 v[162:163], v172 offset:27136
    ds_read_b64_tr_b16 v[164:165], v172 offset:34816
    ds_read_b64_tr_b16 v[166:167], v172 offset:35328
    ds_read_b64_tr_b16 v[168:169], v172 offset:43008
    ds_read_b64_tr_b16 v[170:171], v172 offset:43520
    ds_read_b128 v[144:147], v178 offset:10240
    s_waitcnt lgkmcnt(13)
    v_mfma_f32_32x32x16_bf16 v[20:35], v[148:151], v[132:135], v[20:35]
    s_waitcnt lgkmcnt(11)
    v_mfma_f32_32x32x16_bf16 v[36:51], v[152:155], v[132:135], v[36:51]
    s_waitcnt lgkmcnt(9)
    v_mfma_f32_32x32x16_bf16 v[52:67], v[132:135], v[156:159], v[52:67]
    s_waitcnt lgkmcnt(8)
    s_cbranch_vccnz gated_mix__sliding_local_dilated__grouped_kv_mqa__prompt_kernel_hv21
    v_mfma_f32_32x32x16_bf16 v[68:83], v[152:155], v[140:143], v[68:83]
    s_branch gated_mix__sliding_local_dilated__grouped_kv_mqa__prompt_kernel_hd21
gated_mix__sliding_local_dilated__grouped_kv_mqa__prompt_kernel_hv21:
    v_mfma_f32_32x32x16_bf16 v[68:83], v[140:143], v[156:159], v[68:83]
gated_mix__sliding_local_dilated__grouped_kv_mqa__prompt_kernel_hd21:
    ds_read_b128 v[132:135], v175 offset:40960
    ds_read_b64_tr_b16 v[148:149], v172 offset:28672
    ds_read_b64_tr_b16 v[150:151], v172 offset:29184
    ds_read_b64_tr_b16 v[152:153], v172 offset:36864
    ds_read_b64_tr_b16 v[154:155], v172 offset:37376
    ds_read_b64_tr_b16 v[156:157], v172 offset:45056
    ds_read_b64_tr_b16 v[158:159], v172 offset:45568
    ds_read_b128 v[140:143], v179 offset:10240
    s_waitcnt lgkmcnt(13)
    v_mfma_f32_32x32x16_bf16 v[20:35], v[160:163], v[136:139], v[20:35]
    s_waitcnt lgkmcnt(11)
    v_mfma_f32_32x32x16_bf16 v[36:51], v[164:167], v[136:139], v[36:51]
    s_waitcnt lgkmcnt(9)
    v_mfma_f32_32x32x16_bf16 v[52:67], v[136:139], v[168:171], v[52:67]
    s_waitcnt lgkmcnt(8)
    s_cbranch_vccnz gated_mix__sliding_local_dilated__grouped_kv_mqa__prompt_kernel_hv22
    v_mfma_f32_32x32x16_bf16 v[68:83], v[164:167], v[144:147], v[68:83]
    s_branch gated_mix__sliding_local_dilated__grouped_kv_mqa__prompt_kernel_hd22
gated_mix__sliding_local_dilated__grouped_kv_mqa__prompt_kernel_hv22:
    v_mfma_f32_32x32x16_bf16 v[68:83], v[144:147], v[168:171], v[68:83]
gated_mix__sliding_local_dilated__grouped_kv_mqa__prompt_kernel_hd22:
    ds_read_b128 v[136:139], v176 offset:40960
    ds_read_b64_tr_b16 v[160:161], v172 offset:30720
    ds_read_b64_tr_b16 v[162:163], v172 offset:31232
    ds_read_b64_tr_b16 v[164:165], v172 offset:38912
    ds_read_b64_tr_b16 v[166:167], v172 offset:39424
    ds_read_b64_tr_b16 v[168:169], v172 offset:47104
    ds_read_b64_tr_b16 v[170:171], v172 offset:47616
    ds_read_b128 v[144:147], v180 offset:10240
    s_waitcnt lgkmcnt(13)
    v_mfma_f32_32x32x16_bf16 v[20:35], v[148:151], v[132:135], v[20:35]
    s_waitcnt lgkmcnt(11)
    v_mfma_f32_32x32x16_bf16 v[36:51], v[152:155], v[132:135], v[36:51]
    s_waitcnt lgkmcnt(9)
    v_mfma_f32_32x32x16_bf16 v[52:67], v[132:135], v[156:159], v[52:67]
    s_waitcnt lgkmcnt(8)
    s_cbranch_vccnz gated_mix__sliding_local_dilated__grouped_kv_mqa__prompt_kernel_hv23
    v_mfma_f32_32x32x16_bf16 v[68:83], v[152:155], v[140:143], v[68:83]
    s_branch gated_mix__sliding_local_dilated__grouped_kv_mqa__prompt_kernel_hd23
gated_mix__sliding_local_dilated__grouped_kv_mqa__prompt_kernel_hv23:
    v_mfma_f32_32x32x16_bf16 v[68:83], v[140:143], v[156:159], v[68:83]
gated_mix__sliding_local_dilated__grouped_kv_mqa__prompt_kernel_hd23:
    s_waitcnt lgkmcnt(5)
    v_mfma_f32_32x32x16_bf16 v[20:35], v[160:163], v[136:139], v[20:35]
    s_waitcnt lgkmcnt(3)
    v_mfma_f32_32x32x16_bf16 v[36:51], v[164:167], v[136:139], v[36:51]
    s_waitcnt lgkmcnt(1)
    v_mfma_f32_32x32x16_bf16 v[52:67], v[136:139], v[168:171], v[52:67]
    s_waitcnt lgkmcnt(0)
    s_cbranch_vccnz gated_mix__sliding_local_dilated__grouped_kv_mqa__prompt_kernel_hv24
    v_mfma_f32_32x32x16_bf16 v[68:83], v[164:167], v[144:147], v[68:83]
    s_branch gated_mix__sliding_local_dilated__grouped_kv_mqa__prompt_kernel_hd24
gated_mix__sliding_local_dilated__grouped_kv_mqa__prompt_kernel_hv24:
    v_mfma_f32_32x32x16_bf16 v[68:83], v[144:147], v[168:171], v[68:83]
gated_mix__sliding_local_dilated__grouped_kv_mqa__prompt_kernel_hd24:
    s_waitcnt vmcnt(0)
    s_waitcnt lgkmcnt(0)
    s_barrier
    s_add_u32 m0, s83, 131072
    s_add_u32 s5, s83, 98304
    buffer_load_dwordx4 v4, s[24:27], s5 offen lds
    s_add_u32 m0, s83, 135168
    s_add_u32 s5, s83, 102400
    buffer_load_dwordx4 v4, s[24:27], s5 offen lds
    s_add_u32 s6, s74, 7
    s_and_b32 s6, s6, 7
    s_mul_i32 s7, s6, 196608
    s_add_u32 m0, s84, 106496
    s_add_u32 s5, s7, 0
    buffer_load_dwordx4 v128, s[28:31], s5 offen lds
    s_add_u32 m0, s84, 107520
    s_add_u32 s5, s7, 24576
    buffer_load_dwordx4 v128, s[28:31], s5 offen lds
    s_add_u32 m0, s84, 114688
    s_add_u32 s5, s7, 1024
    buffer_load_dwordx4 v128, s[28:31], s5 offen lds
    s_add_u32 m0, s84, 115712
    s_add_u32 s5, s7, 25600
    buffer_load_dwordx4 v128, s[28:31], s5 offen lds
    s_add_u32 m0, s84, 122880
    s_add_u32 s5, s7, 2048
    buffer_load_dwordx4 v128, s[28:31], s5 offen lds
    s_add_u32 m0, s84, 123904
    s_add_u32 s5, s7, 26624
    buffer_load_dwordx4 v128, s[28:31], s5 offen lds
    s_mov_b64 vcc, s[70:71]
    ds_read_b128 v[132:135], v173 offset:49152
    ds_read_b64_tr_b16 v[148:149], v172 offset:0
    ds_read_b64_tr_b16 v[150:151], v172 offset:512
    ds_read_b64_tr_b16 v[152:153], v172 offset:8192
    ds_read_b64_tr_b16 v[154:155], v172 offset:8704
    ds_read_b64_tr_b16 v[156:157], v172 offset:16384
    ds_read_b64_tr_b16 v[158:159], v172 offset:16896
    ds_read_b128 v[140:143], v177 offset:12288
    ds_read_b128 v[136:139], v174 offset:49152
    ds_read_b64_tr_b16 v[160:161], v172 offset:2048
    ds_read_b64_tr_b16 v[162:163], v172 offset:2560
    ds_read_b64_tr_b16 v[164:165], v172 offset:10240
    ds_read_b64_tr_b16 v[166:167], v172 offset:10752
    ds_read_b64_tr_b16 v[168:169], v172 offset:18432
    ds_read_b64_tr_b16 v[170:171], v172 offset:18944
    ds_read_b128 v[144:147], v178 offset:12288
    s_waitcnt lgkmcnt(13)
    v_mfma_f32_32x32x16_bf16 v[20:35], v[148:151], v[132:135], v[20:35]
    s_waitcnt lgkmcnt(11)
    v_mfma_f32_32x32x16_bf16 v[36:51], v[152:155], v[132:135], v[36:51]
    s_waitcnt lgkmcnt(9)
    v_mfma_f32_32x32x16_bf16 v[52:67], v[132:135], v[156:159], v[52:67]
    s_waitcnt lgkmcnt(8)
    s_cbranch_vccnz gated_mix__sliding_local_dilated__grouped_kv_mqa__prompt_kernel_hv25
    v_mfma_f32_32x32x16_bf16 v[68:83], v[152:155], v[140:143], v[68:83]
    s_branch gated_mix__sliding_local_dilated__grouped_kv_mqa__prompt_kernel_hd25
gated_mix__sliding_local_dilated__grouped_kv_mqa__prompt_kernel_hv25:
    v_mfma_f32_32x32x16_bf16 v[68:83], v[140:143], v[156:159], v[68:83]
gated_mix__sliding_local_dilated__grouped_kv_mqa__prompt_kernel_hd25:
    ds_read_b128 v[132:135], v175 offset:49152
    ds_read_b64_tr_b16 v[148:149], v172 offset:4096
    ds_read_b64_tr_b16 v[150:151], v172 offset:4608
    ds_read_b64_tr_b16 v[152:153], v172 offset:12288
    ds_read_b64_tr_b16 v[154:155], v172 offset:12800
    ds_read_b64_tr_b16 v[156:157], v172 offset:20480
    ds_read_b64_tr_b16 v[158:159], v172 offset:20992
    ds_read_b128 v[140:143], v179 offset:12288
    s_waitcnt lgkmcnt(13)
    v_mfma_f32_32x32x16_bf16 v[20:35], v[160:163], v[136:139], v[20:35]
    s_waitcnt lgkmcnt(11)
    v_mfma_f32_32x32x16_bf16 v[36:51], v[164:167], v[136:139], v[36:51]
    s_waitcnt lgkmcnt(9)
    v_mfma_f32_32x32x16_bf16 v[52:67], v[136:139], v[168:171], v[52:67]
    s_waitcnt lgkmcnt(8)
    s_cbranch_vccnz gated_mix__sliding_local_dilated__grouped_kv_mqa__prompt_kernel_hv26
    v_mfma_f32_32x32x16_bf16 v[68:83], v[164:167], v[144:147], v[68:83]
    s_branch gated_mix__sliding_local_dilated__grouped_kv_mqa__prompt_kernel_hd26
gated_mix__sliding_local_dilated__grouped_kv_mqa__prompt_kernel_hv26:
    v_mfma_f32_32x32x16_bf16 v[68:83], v[144:147], v[168:171], v[68:83]
gated_mix__sliding_local_dilated__grouped_kv_mqa__prompt_kernel_hd26:
    ds_read_b128 v[136:139], v176 offset:49152
    ds_read_b64_tr_b16 v[160:161], v172 offset:6144
    ds_read_b64_tr_b16 v[162:163], v172 offset:6656
    ds_read_b64_tr_b16 v[164:165], v172 offset:14336
    ds_read_b64_tr_b16 v[166:167], v172 offset:14848
    ds_read_b64_tr_b16 v[168:169], v172 offset:22528
    ds_read_b64_tr_b16 v[170:171], v172 offset:23040
    ds_read_b128 v[144:147], v180 offset:12288
    s_waitcnt lgkmcnt(13)
    v_mfma_f32_32x32x16_bf16 v[20:35], v[148:151], v[132:135], v[20:35]
    s_waitcnt lgkmcnt(11)
    v_mfma_f32_32x32x16_bf16 v[36:51], v[152:155], v[132:135], v[36:51]
    s_waitcnt lgkmcnt(9)
    v_mfma_f32_32x32x16_bf16 v[52:67], v[132:135], v[156:159], v[52:67]
    s_waitcnt lgkmcnt(8)
    s_cbranch_vccnz gated_mix__sliding_local_dilated__grouped_kv_mqa__prompt_kernel_hv27
    v_mfma_f32_32x32x16_bf16 v[68:83], v[152:155], v[140:143], v[68:83]
    s_branch gated_mix__sliding_local_dilated__grouped_kv_mqa__prompt_kernel_hd27
gated_mix__sliding_local_dilated__grouped_kv_mqa__prompt_kernel_hv27:
    v_mfma_f32_32x32x16_bf16 v[68:83], v[140:143], v[156:159], v[68:83]
gated_mix__sliding_local_dilated__grouped_kv_mqa__prompt_kernel_hd27:
    s_waitcnt lgkmcnt(5)
    v_mfma_f32_32x32x16_bf16 v[20:35], v[160:163], v[136:139], v[20:35]
    s_waitcnt lgkmcnt(3)
    v_mfma_f32_32x32x16_bf16 v[36:51], v[164:167], v[136:139], v[36:51]
    s_waitcnt lgkmcnt(1)
    v_mfma_f32_32x32x16_bf16 v[52:67], v[136:139], v[168:171], v[52:67]
    s_waitcnt lgkmcnt(0)
    s_cbranch_vccnz gated_mix__sliding_local_dilated__grouped_kv_mqa__prompt_kernel_hv28
    v_mfma_f32_32x32x16_bf16 v[68:83], v[164:167], v[144:147], v[68:83]
    s_branch gated_mix__sliding_local_dilated__grouped_kv_mqa__prompt_kernel_hd28
gated_mix__sliding_local_dilated__grouped_kv_mqa__prompt_kernel_hv28:
    v_mfma_f32_32x32x16_bf16 v[68:83], v[144:147], v[168:171], v[68:83]
gated_mix__sliding_local_dilated__grouped_kv_mqa__prompt_kernel_hd28:
    s_waitcnt vmcnt(0)
    s_waitcnt lgkmcnt(0)
    s_barrier
    s_add_u32 m0, s83, 139264
    s_add_u32 s5, s83, 106496
    buffer_load_dwordx4 v4, s[24:27], s5 offen lds
    s_add_u32 m0, s83, 143360
    s_add_u32 s5, s83, 110592
    buffer_load_dwordx4 v4, s[24:27], s5 offen lds
    s_mov_b64 vcc, s[70:71]
    ds_read_b128 v[132:135], v173 offset:57344
    ds_read_b64_tr_b16 v[148:149], v172 offset:24576
    ds_read_b64_tr_b16 v[150:151], v172 offset:25088
    ds_read_b64_tr_b16 v[152:153], v172 offset:32768
    ds_read_b64_tr_b16 v[154:155], v172 offset:33280
    ds_read_b64_tr_b16 v[156:157], v172 offset:40960
    ds_read_b64_tr_b16 v[158:159], v172 offset:41472
    ds_read_b128 v[140:143], v177 offset:14336
    ds_read_b128 v[136:139], v174 offset:57344
    ds_read_b64_tr_b16 v[160:161], v172 offset:26624
    ds_read_b64_tr_b16 v[162:163], v172 offset:27136
    ds_read_b64_tr_b16 v[164:165], v172 offset:34816
    ds_read_b64_tr_b16 v[166:167], v172 offset:35328
    ds_read_b64_tr_b16 v[168:169], v172 offset:43008
    ds_read_b64_tr_b16 v[170:171], v172 offset:43520
    ds_read_b128 v[144:147], v178 offset:14336
    s_waitcnt lgkmcnt(13)
    v_mfma_f32_32x32x16_bf16 v[20:35], v[148:151], v[132:135], v[20:35]
    s_waitcnt lgkmcnt(11)
    v_mfma_f32_32x32x16_bf16 v[36:51], v[152:155], v[132:135], v[36:51]
    s_waitcnt lgkmcnt(9)
    v_mfma_f32_32x32x16_bf16 v[52:67], v[132:135], v[156:159], v[52:67]
    s_waitcnt lgkmcnt(8)
    s_cbranch_vccnz gated_mix__sliding_local_dilated__grouped_kv_mqa__prompt_kernel_hv29
    v_mfma_f32_32x32x16_bf16 v[68:83], v[152:155], v[140:143], v[68:83]
    s_branch gated_mix__sliding_local_dilated__grouped_kv_mqa__prompt_kernel_hd29
gated_mix__sliding_local_dilated__grouped_kv_mqa__prompt_kernel_hv29:
    v_mfma_f32_32x32x16_bf16 v[68:83], v[140:143], v[156:159], v[68:83]
gated_mix__sliding_local_dilated__grouped_kv_mqa__prompt_kernel_hd29:
    ds_read_b128 v[132:135], v175 offset:57344
    ds_read_b64_tr_b16 v[148:149], v172 offset:28672
    ds_read_b64_tr_b16 v[150:151], v172 offset:29184
    ds_read_b64_tr_b16 v[152:153], v172 offset:36864
    ds_read_b64_tr_b16 v[154:155], v172 offset:37376
    ds_read_b64_tr_b16 v[156:157], v172 offset:45056
    ds_read_b64_tr_b16 v[158:159], v172 offset:45568
    ds_read_b128 v[140:143], v179 offset:14336
    s_waitcnt lgkmcnt(13)
    v_mfma_f32_32x32x16_bf16 v[20:35], v[160:163], v[136:139], v[20:35]
    s_waitcnt lgkmcnt(11)
    v_mfma_f32_32x32x16_bf16 v[36:51], v[164:167], v[136:139], v[36:51]
    s_waitcnt lgkmcnt(9)
    v_mfma_f32_32x32x16_bf16 v[52:67], v[136:139], v[168:171], v[52:67]
    s_waitcnt lgkmcnt(8)
    s_cbranch_vccnz gated_mix__sliding_local_dilated__grouped_kv_mqa__prompt_kernel_hv30
    v_mfma_f32_32x32x16_bf16 v[68:83], v[164:167], v[144:147], v[68:83]
    s_branch gated_mix__sliding_local_dilated__grouped_kv_mqa__prompt_kernel_hd30
gated_mix__sliding_local_dilated__grouped_kv_mqa__prompt_kernel_hv30:
    v_mfma_f32_32x32x16_bf16 v[68:83], v[144:147], v[168:171], v[68:83]
gated_mix__sliding_local_dilated__grouped_kv_mqa__prompt_kernel_hd30:
    ds_read_b128 v[136:139], v176 offset:57344
    ds_read_b64_tr_b16 v[160:161], v172 offset:30720
    ds_read_b64_tr_b16 v[162:163], v172 offset:31232
    ds_read_b64_tr_b16 v[164:165], v172 offset:38912
    ds_read_b64_tr_b16 v[166:167], v172 offset:39424
    ds_read_b64_tr_b16 v[168:169], v172 offset:47104
    ds_read_b64_tr_b16 v[170:171], v172 offset:47616
    ds_read_b128 v[144:147], v180 offset:14336
    s_waitcnt lgkmcnt(13)
    v_mfma_f32_32x32x16_bf16 v[20:35], v[148:151], v[132:135], v[20:35]
    s_waitcnt lgkmcnt(11)
    v_mfma_f32_32x32x16_bf16 v[36:51], v[152:155], v[132:135], v[36:51]
    s_waitcnt lgkmcnt(9)
    v_mfma_f32_32x32x16_bf16 v[52:67], v[132:135], v[156:159], v[52:67]
    s_waitcnt lgkmcnt(8)
    s_cbranch_vccnz gated_mix__sliding_local_dilated__grouped_kv_mqa__prompt_kernel_hv31
    v_mfma_f32_32x32x16_bf16 v[68:83], v[152:155], v[140:143], v[68:83]
    s_branch gated_mix__sliding_local_dilated__grouped_kv_mqa__prompt_kernel_hd31
gated_mix__sliding_local_dilated__grouped_kv_mqa__prompt_kernel_hv31:
    v_mfma_f32_32x32x16_bf16 v[68:83], v[140:143], v[156:159], v[68:83]
gated_mix__sliding_local_dilated__grouped_kv_mqa__prompt_kernel_hd31:
    s_waitcnt lgkmcnt(5)
    v_mfma_f32_32x32x16_bf16 v[20:35], v[160:163], v[136:139], v[20:35]
    s_waitcnt lgkmcnt(3)
    v_mfma_f32_32x32x16_bf16 v[36:51], v[164:167], v[136:139], v[36:51]
    s_waitcnt lgkmcnt(1)
    v_mfma_f32_32x32x16_bf16 v[52:67], v[136:139], v[168:171], v[52:67]
    s_waitcnt lgkmcnt(0)
    s_cbranch_vccnz gated_mix__sliding_local_dilated__grouped_kv_mqa__prompt_kernel_hv32
    v_mfma_f32_32x32x16_bf16 v[68:83], v[164:167], v[144:147], v[68:83]
    s_branch gated_mix__sliding_local_dilated__grouped_kv_mqa__prompt_kernel_hd32
gated_mix__sliding_local_dilated__grouped_kv_mqa__prompt_kernel_hv32:
    v_mfma_f32_32x32x16_bf16 v[68:83], v[144:147], v[168:171], v[68:83]
gated_mix__sliding_local_dilated__grouped_kv_mqa__prompt_kernel_hd32:
    s_setprio 2
    s_lshl_b32 s5, s69, 7
    s_lshl_b32 s7, s85, 17
    s_add_u32 s5, s5, s7
    v_add_u32 v195, s5, v11
    s_lshl_b32 s81, s85, 14
    s_nop 7
    v_cvt_pk_bf16_f32 v132, v36, v37
    v_cvt_pk_bf16_f32 v133, v38, v39
    v_cvt_pk_bf16_f32 v134, v40, v41
    v_cvt_pk_bf16_f32 v135, v42, v43
    v_cvt_pk_bf16_f32 v136, v44, v45
    v_cvt_pk_bf16_f32 v137, v46, v47
    v_cvt_pk_bf16_f32 v138, v48, v49
    v_cvt_pk_bf16_f32 v139, v50, v51
    v_cvt_pk_bf16_f32 v140, v52, v53
    v_cvt_pk_bf16_f32 v141, v54, v55
    v_cvt_pk_bf16_f32 v142, v56, v57
    v_cvt_pk_bf16_f32 v143, v58, v59
    v_cvt_pk_bf16_f32 v144, v60, v61
    v_cvt_pk_bf16_f32 v145, v62, v63
    v_cvt_pk_bf16_f32 v146, v64, v65
    v_cvt_pk_bf16_f32 v147, v66, v67
    v_cvt_pk_bf16_f32 v156, v68, v69
    v_cvt_pk_bf16_f32 v157, v70, v71
    v_cvt_pk_bf16_f32 v158, v72, v73
    v_cvt_pk_bf16_f32 v159, v74, v75
    v_cvt_pk_bf16_f32 v160, v76, v77
    v_cvt_pk_bf16_f32 v161, v78, v79
    v_cvt_pk_bf16_f32 v162, v80, v81
    v_cvt_pk_bf16_f32 v163, v82, v83
    s_lshl_b32 s4, s85, 12
    s_add_u32 s4, s4, 81920
    v_add_u32 v192, s4, v4
    ds_write_b128 v192, v[132:135]
    ds_write_b128 v192, v[136:139] offset:1024
    ds_write_b128 v192, v[144:147] offset:2048
    ds_write_b128 v192, v[160:163] offset:3072
    v_xor_b32 v192, 4096, v192
    v_mul_f32 v20, s76, v20
    v_mul_f32 v21, s76, v21
    v_mul_f32 v22, s76, v22
    v_mul_f32 v23, s76, v23
    v_mul_f32 v24, s76, v24
    v_mul_f32 v25, s76, v25
    v_mul_f32 v26, s76, v26
    v_mul_f32 v27, s76, v27
    v_mul_f32 v28, s76, v28
    v_mul_f32 v29, s76, v29
    v_mul_f32 v30, s76, v30
    v_mul_f32 v31, s76, v31
    v_mul_f32 v32, s76, v32
    v_mul_f32 v33, s76, v33
    v_mul_f32 v34, s76, v34
    v_mul_f32 v35, s76, v35
    v_cvt_pk_bf16_f32 v148, v20, v21
    v_cvt_pk_bf16_f32 v149, v22, v23
    v_cvt_pk_bf16_f32 v150, v24, v25
    v_cvt_pk_bf16_f32 v151, v26, v27
    v_cvt_pk_bf16_f32 v152, v28, v29
    v_cvt_pk_bf16_f32 v153, v30, v31
    v_cvt_pk_bf16_f32 v154, v32, v33
    v_cvt_pk_bf16_f32 v155, v34, v35
    v_mov_b32 v188, 0x3f803f80
    v_mov_b32 v189, 0x3f803f80
    v_mov_b32 v190, 0x3f803f80
    v_mov_b32 v191, 0x3f803f80
    s_waitcnt lgkmcnt(0)
    s_barrier
    s_bitcmp1_b32 s85, 0
    s_cbranch_scc1 gated_mix__sliding_local_dilated__grouped_kv_mqa__prompt_kernel_ex1
    ds_read_b128 v[164:167], v192 offset:3072
    s_branch gated_mix__sliding_local_dilated__grouped_kv_mqa__prompt_kernel_ex2
gated_mix__sliding_local_dilated__grouped_kv_mqa__prompt_kernel_ex1:
    ds_read_b128 v[156:159], v192
    ds_read_b128 v[160:163], v192 offset:1024
    ds_read_b128 v[164:167], v192 offset:2048
gated_mix__sliding_local_dilated__grouped_kv_mqa__prompt_kernel_ex2:
    s_add_u32 m0, s83, 147456
    s_add_u32 s5, s83, 114688
    buffer_load_dwordx4 v4, s[24:27], s5 offen lds
    s_add_u32 m0, s83, 151552
    s_add_u32 s5, s83, 118784
    buffer_load_dwordx4 v4, s[24:27], s5 offen lds
    s_and_b32 s4, s85, 1
    s_lshl_b32 s5, s69, 2
    s_and_b32 s6, s85, 2
    s_add_u32 s5, s5, s6
    s_lshl_b32 s6, s4, 5
    s_add_u32 s5, s5, s6
    s_lshl_b32 s5, s5, 10
    s_lshl_b32 s6, s68, 16
    s_add_u32 s6, s6, s5
    s_lshl_b32 s4, s68, 10
    s_lshl_b32 s7, s69, 4
    s_add_u32 s4, s4, s7
    s_lshl_b32 s7, s85, 2
    s_add_u32 s4, s4, s7
    s_add_u32 s82, s6, 1048576
    s_add_u32 s71, s4, 393216
    s_waitcnt lgkmcnt(0)
    v_mfma_f32_32x32x16_bf16 v[20:35], v[132:135], v[148:151], v[84:99]
    v_mfma_f32_32x32x16_bf16 v[36:51], v[156:159], v[148:151], v[92:107]
    v_mfma_f32_32x32x16_bf16 v[196:211], v[136:139], v[152:155], v[84:99]
    v_mfma_f32_32x32x16_bf16 v[212:227], v[160:163], v[152:155], v[92:107]
    s_add_u32 m0, s81, 0
    s_mov_b32 s5, 0
    buffer_load_dwordx4 v195, s[32:35], s5 offen lds
    s_add_u32 m0, s81, 1024
    s_mov_b32 s5, 8192
    buffer_load_dwordx4 v195, s[32:35], s5 offen lds
    s_add_u32 m0, s81, 2048
    s_mov_b32 s5, 16384
    buffer_load_dwordx4 v195, s[32:35], s5 offen lds
    s_add_u32 m0, s81, 3072
    s_mov_b32 s5, 24576
    buffer_load_dwordx4 v195, s[32:35], s5 offen lds
    v_max3_f32 v193, v20, v21, v22
    v_max3_f32 v193, v193, v23, v24
    v_max3_f32 v193, v193, v25, v26
    v_max3_f32 v193, v193, v27, v28
    v_max3_f32 v193, v193, v29, v30
    v_max3_f32 v193, v193, v31, v32
    v_max3_f32 v193, v193, v33, v34
    v_max3_f32 v193, v193, v35, v44
    v_max3_f32 v193, v193, v45, v46
    v_max3_f32 v193, v193, v47, v48
    v_max3_f32 v193, v193, v49, v50
    v_max_f32 v193, v193, v51
    v_mov_b32 v5, v193
    s_nop 1
    v_permlane32_swap_b32 v193, v5
    s_nop 1
    v_max_f32 v193, v193, v5
    v_sub_f32 v20, v20, v193
    v_sub_f32 v21, v21, v193
    v_sub_f32 v22, v22, v193
    v_sub_f32 v23, v23, v193
    v_sub_f32 v24, v24, v193
    v_sub_f32 v25, v25, v193
    v_sub_f32 v26, v26, v193
    v_sub_f32 v27, v27, v193
    v_sub_f32 v28, v28, v193
    v_sub_f32 v29, v29, v193
    v_sub_f32 v30, v30, v193
    v_sub_f32 v31, v31, v193
    v_sub_f32 v32, v32, v193
    v_sub_f32 v33, v33, v193
    v_sub_f32 v34, v34, v193
    v_sub_f32 v35, v35, v193
    v_sub_f32 v44, v44, v193
    v_sub_f32 v45, v45, v193
    v_sub_f32 v46, v46, v193
    v_sub_f32 v47, v47, v193
    v_sub_f32 v48, v48, v193
    v_sub_f32 v49, v49, v193
    v_sub_f32 v50, v50, v193
    v_sub_f32 v51, v51, v193
    v_exp_f32 v20, v20
    v_exp_f32 v21, v21
    v_exp_f32 v22, v22
    v_exp_f32 v23, v23
    v_exp_f32 v24, v24
    v_exp_f32 v25, v25
    v_exp_f32 v26, v26
    v_exp_f32 v27, v27
    v_exp_f32 v28, v28
    v_exp_f32 v29, v29
    v_exp_f32 v30, v30
    v_exp_f32 v31, v31
    v_exp_f32 v32, v32
    v_exp_f32 v33, v33
    v_exp_f32 v34, v34
    v_exp_f32 v35, v35
    v_exp_f32 v44, v44
    v_exp_f32 v45, v45
    v_exp_f32 v46, v46
    v_exp_f32 v47, v47
    v_exp_f32 v48, v48
    v_exp_f32 v49, v49
    v_exp_f32 v50, v50
    v_exp_f32 v51, v51
    s_nop 0
    v_cvt_pk_bf16_f32 v168, v20, v21
    v_cvt_pk_bf16_f32 v169, v22, v23
    v_cvt_pk_bf16_f32 v170, v24, v25
    v_cvt_pk_bf16_f32 v171, v26, v27
    v_cvt_pk_bf16_f32 v172, v28, v29
    v_cvt_pk_bf16_f32 v173, v30, v31
    v_cvt_pk_bf16_f32 v174, v32, v33
    v_cvt_pk_bf16_f32 v175, v34, v35
    v_cvt_pk_bf16_f32 v176, v44, v45
    v_cvt_pk_bf16_f32 v177, v46, v47
    v_cvt_pk_bf16_f32 v178, v48, v49
    v_cvt_pk_bf16_f32 v179, v50, v51
    s_nop 1
    v_mfma_f32_32x32x16_bf16 v[20:35], v[140:143], v[168:171], 0
    v_mfma_f32_32x32x16_bf16 v[36:51], v[188:191], v[168:171], 0
    v_mfma_f32_32x32x16_bf16 v[20:35], v[144:147], v[172:175], v[20:35]
    v_mfma_f32_32x32x16_bf16 v[36:51], v[188:191], v[172:175], v[36:51]
    v_mfma_f32_32x32x16_bf16 v[20:35], v[164:167], v[176:179], v[20:35]
    v_mfma_f32_32x32x16_bf16 v[36:51], v[188:191], v[176:179], v[36:51]
    v_max3_f32 v193, v196, v197, v198
    v_max3_f32 v193, v193, v199, v200
    v_max3_f32 v193, v193, v201, v202
    v_max3_f32 v193, v193, v203, v204
    v_max3_f32 v193, v193, v205, v206
    v_max3_f32 v193, v193, v207, v208
    v_max3_f32 v193, v193, v209, v210
    v_max3_f32 v193, v193, v211, v220
    v_max3_f32 v193, v193, v221, v222
    v_max3_f32 v193, v193, v223, v224
    v_max3_f32 v193, v193, v225, v226
    v_max_f32 v193, v193, v227
    v_mov_b32 v5, v193
    s_nop 1
    v_permlane32_swap_b32 v193, v5
    s_nop 1
    v_max_f32 v193, v193, v5
    v_sub_f32 v196, v196, v193
    v_sub_f32 v197, v197, v193
    v_sub_f32 v198, v198, v193
    v_sub_f32 v199, v199, v193
    v_sub_f32 v200, v200, v193
    v_sub_f32 v201, v201, v193
    v_sub_f32 v202, v202, v193
    v_sub_f32 v203, v203, v193
    v_sub_f32 v204, v204, v193
    v_sub_f32 v205, v205, v193
    v_sub_f32 v206, v206, v193
    v_sub_f32 v207, v207, v193
    v_sub_f32 v208, v208, v193
    v_sub_f32 v209, v209, v193
    v_sub_f32 v210, v210, v193
    v_sub_f32 v211, v211, v193
    v_sub_f32 v220, v220, v193
    v_sub_f32 v221, v221, v193
    v_sub_f32 v222, v222, v193
    v_sub_f32 v223, v223, v193
    v_sub_f32 v224, v224, v193
    v_sub_f32 v225, v225, v193
    v_sub_f32 v226, v226, v193
    v_sub_f32 v227, v227, v193
    v_exp_f32 v196, v196
    v_exp_f32 v197, v197
    v_exp_f32 v198, v198
    v_exp_f32 v199, v199
    v_exp_f32 v200, v200
    v_exp_f32 v201, v201
    v_exp_f32 v202, v202
    v_exp_f32 v203, v203
    v_exp_f32 v204, v204
    v_exp_f32 v205, v205
    v_exp_f32 v206, v206
    v_exp_f32 v207, v207
    v_exp_f32 v208, v208
    v_exp_f32 v209, v209
    v_exp_f32 v210, v210
    v_exp_f32 v211, v211
    v_exp_f32 v220, v220
    v_exp_f32 v221, v221
    v_exp_f32 v222, v222
    v_exp_f32 v223, v223
    v_exp_f32 v224, v224
    v_exp_f32 v225, v225
    v_exp_f32 v226, v226
    v_exp_f32 v227, v227
    s_nop 0
    v_cvt_pk_bf16_f32 v228, v196, v197
    v_cvt_pk_bf16_f32 v229, v198, v199
    v_cvt_pk_bf16_f32 v230, v200, v201
    v_cvt_pk_bf16_f32 v231, v202, v203
    v_cvt_pk_bf16_f32 v232, v204, v205
    v_cvt_pk_bf16_f32 v233, v206, v207
    v_cvt_pk_bf16_f32 v234, v208, v209
    v_cvt_pk_bf16_f32 v235, v210, v211
    v_cvt_pk_bf16_f32 v236, v220, v221
    v_cvt_pk_bf16_f32 v237, v222, v223
    v_cvt_pk_bf16_f32 v238, v224, v225
    v_cvt_pk_bf16_f32 v239, v226, v227
    s_nop 1
    v_mfma_f32_32x32x16_bf16 v[196:211], v[140:143], v[228:231], 0
    v_mfma_f32_32x32x16_bf16 v[212:227], v[188:191], v[228:231], 0
    v_mfma_f32_32x32x16_bf16 v[196:211], v[144:147], v[232:235], v[196:211]
    v_mfma_f32_32x32x16_bf16 v[212:227], v[188:191], v[232:235], v[212:227]
    v_mfma_f32_32x32x16_bf16 v[196:211], v[164:167], v[236:239], v[196:211]
    v_mfma_f32_32x32x16_bf16 v[212:227], v[188:191], v[236:239], v[212:227]
    v_rcp_f32 v194, v36
    s_nop 0
    v_mul_f32 v20, v20, v194
    v_mul_f32 v21, v21, v194
    v_mul_f32 v22, v22, v194
    v_mul_f32 v23, v23, v194
    v_mul_f32 v24, v24, v194
    v_mul_f32 v25, v25, v194
    v_mul_f32 v26, v26, v194
    v_mul_f32 v27, v27, v194
    v_cvt_pk_bf16_f32 v180, v20, v21
    v_cvt_pk_bf16_f32 v181, v22, v23
    v_cvt_pk_bf16_f32 v182, v24, v25
    v_cvt_pk_bf16_f32 v183, v26, v27
    buffer_store_dwordx4 v[180:183], v4, s[24:27], s82 offen offset:0 sc1
    s_nop 7
    v_rcp_f32 v194, v212
    s_nop 0
    v_mul_f32 v204, v204, v194
    v_mul_f32 v205, v205, v194
    v_mul_f32 v206, v206, v194
    v_mul_f32 v207, v207, v194
    v_mul_f32 v208, v208, v194
    v_mul_f32 v209, v209, v194
    v_mul_f32 v210, v210, v194
    v_mul_f32 v211, v211, v194
    v_cvt_pk_bf16_f32 v184, v204, v205
    v_cvt_pk_bf16_f32 v185, v206, v207
    v_cvt_pk_bf16_f32 v186, v208, v209
    v_cvt_pk_bf16_f32 v187, v210, v211
    buffer_store_dwordx4 v[184:187], v4, s[24:27], s82 offen offset:1024 sc1
    s_waitcnt vmcnt(8)
    s_waitcnt lgkmcnt(0)
    s_barrier
    s_add_u32 m0, s83, 155648
    s_add_u32 s5, s83, 122880
    buffer_load_dwordx4 v4, s[24:27], s5 offen lds
    s_add_u32 m0, s83, 159744
    s_add_u32 s5, s83, 126976
    buffer_load_dwordx4 v4, s[24:27], s5 offen lds
    v_mov_b32 v5, s75
    v_lshrrev_b32 v6, 3, v1
    v_lshlrev_b32 v6, 24, v6
    v_lshl_add_u32 v6, v1, 7, v6
    s_waitcnt vmcnt(2)
    buffer_store_dword v5, v6, s[24:27], s71 offen sc1
    s_add_u32 m0, s81, 4096
    s_mov_b32 s5, 32768
    buffer_load_dwordx4 v195, s[32:35], s5 offen lds
    s_add_u32 m0, s81, 5120
    s_mov_b32 s5, 40960
    buffer_load_dwordx4 v195, s[32:35], s5 offen lds
    s_add_u32 m0, s81, 6144
    s_mov_b32 s5, 49152
    buffer_load_dwordx4 v195, s[32:35], s5 offen lds
    s_add_u32 m0, s81, 7168
    s_mov_b32 s5, 57344
    buffer_load_dwordx4 v195, s[32:35], s5 offen lds
    s_add_u32 m0, s81, 8192
    s_mov_b32 s5, 65536
    buffer_load_dwordx4 v195, s[32:35], s5 offen lds
    s_add_u32 m0, s81, 9216
    s_mov_b32 s5, 73728
    buffer_load_dwordx4 v195, s[32:35], s5 offen lds
    s_add_u32 m0, s81, 10240
    s_mov_b32 s5, 81920
    buffer_load_dwordx4 v195, s[32:35], s5 offen lds
    s_add_u32 m0, s81, 11264
    s_mov_b32 s5, 90112
    buffer_load_dwordx4 v195, s[32:35], s5 offen lds
    s_add_u32 m0, s81, 12288
    s_mov_b32 s5, 98304
    buffer_load_dwordx4 v195, s[32:35], s5 offen lds
    s_add_u32 m0, s81, 13312
    s_mov_b32 s5, 106496
    buffer_load_dwordx4 v195, s[32:35], s5 offen lds
    s_waitcnt lgkmcnt(0)
    s_barrier
    s_lshl_b32 s70, s68, 10
    s_lshl_b32 s5, s69, 7
    s_add_u32 s70, s70, s5
    s_lshr_b32 s5, s85, 1
    s_lshl_b32 s6, s5, 2
    s_add_u32 s70, s70, s6
    s_add_u32 s70, s70, 393216
    v_and_b32 v5, 15, v1
    v_lshlrev_b32 v5, 3, v5
    s_lshl_b32 s82, s5, 15
    s_add_u32 s82, s82, s80
    s_add_u32 s82, s82, 1048576
    s_mov_b32 s77, 0
    buffer_load_dword v6, v5, s[24:27], s70 offen sc1
    s_add_u32 m0, s81, 14336
    s_mov_b32 s5, 114688
    buffer_load_dwordx4 v195, s[32:35], s5 offen lds
    s_add_u32 m0, s81, 15360
    s_mov_b32 s5, 122880
    buffer_load_dwordx4 v195, s[32:35], s5 offen lds
    s_add_u32 m0, s81, 65536
    s_mov_b32 s5, 0
    buffer_load_dwordx4 v195, s[36:39], s5 offen lds
    s_add_u32 m0, s81, 66560
    s_mov_b32 s5, 8192
    buffer_load_dwordx4 v195, s[36:39], s5 offen lds
    s_add_u32 m0, s81, 67584
    s_mov_b32 s5, 16384
    buffer_load_dwordx4 v195, s[36:39], s5 offen lds
    s_add_u32 m0, s81, 68608
    s_mov_b32 s5, 24576
    buffer_load_dwordx4 v195, s[36:39], s5 offen lds
    s_waitcnt vmcnt(6)
    s_branch gated_mix__sliding_local_dilated__grouped_kv_mqa__prompt_kernel_poll2_chk
gated_mix__sliding_local_dilated__grouped_kv_mqa__prompt_kernel_poll2:
    buffer_load_dword v6, v5, s[24:27], s70 offen sc1
    s_waitcnt vmcnt(0)
gated_mix__sliding_local_dilated__grouped_kv_mqa__prompt_kernel_poll2_chk:
    v_cmp_ne_u32 vcc, s75, v6
    s_add_u32 s77, s77, 1
    s_cmp_ge_u32 s77, 200000
    s_cbranch_scc1 gated_mix__sliding_local_dilated__grouped_kv_mqa__prompt_kernel_poll2_done
    s_cbranch_vccz gated_mix__sliding_local_dilated__grouped_kv_mqa__prompt_kernel_poll2_done
    s_sleep 4
    s_branch gated_mix__sliding_local_dilated__grouped_kv_mqa__prompt_kernel_poll2
gated_mix__sliding_local_dilated__grouped_kv_mqa__prompt_kernel_poll2_done:
    s_add_u32 s5, s82, 0
    buffer_load_dwordx4 v[20:23], v4, s[24:27], s5 offen offset:0
    buffer_load_dwordx4 v[24:27], v4, s[24:27], s5 offen offset:1024
    buffer_load_dwordx4 v[28:31], v4, s[24:27], s5 offen offset:2048
    buffer_load_dwordx4 v[32:35], v4, s[24:27], s5 offen offset:3072
    s_add_u32 s5, s82, 4096
    buffer_load_dwordx4 v[36:39], v4, s[24:27], s5 offen offset:0
    buffer_load_dwordx4 v[40:43], v4, s[24:27], s5 offen offset:1024
    buffer_load_dwordx4 v[44:47], v4, s[24:27], s5 offen offset:2048
    buffer_load_dwordx4 v[48:51], v4, s[24:27], s5 offen offset:3072
    s_and_b32 s4, s85, 1
    s_lshl_b32 s4, s4, 6
    v_xor_b32 v192, s4, v13
    s_waitcnt lgkmcnt(0)
    s_barrier
    s_add_u32 s5, s82, 8192
    buffer_load_dwordx4 v[52:55], v4, s[24:27], s5 offen offset:0
    buffer_load_dwordx4 v[56:59], v4, s[24:27], s5 offen offset:1024
    buffer_load_dwordx4 v[60:63], v4, s[24:27], s5 offen offset:2048
    buffer_load_dwordx4 v[64:67], v4, s[24:27], s5 offen offset:3072
    s_add_u32 s5, s82, 12288
    buffer_load_dwordx4 v[68:71], v4, s[24:27], s5 offen offset:0
    buffer_load_dwordx4 v[72:75], v4, s[24:27], s5 offen offset:1024
    buffer_load_dwordx4 v[76:79], v4, s[24:27], s5 offen offset:2048
    buffer_load_dwordx4 v[80:83], v4, s[24:27], s5 offen offset:3072
    s_add_u32 m0, s81, 69632
    s_mov_b32 s5, 32768
    buffer_load_dwordx4 v195, s[36:39], s5 offen lds
    s_add_u32 m0, s81, 70656
    s_mov_b32 s5, 40960
    buffer_load_dwordx4 v195, s[36:39], s5 offen lds
    s_add_u32 m0, s81, 71680
    s_mov_b32 s5, 49152
    buffer_load_dwordx4 v195, s[36:39], s5 offen lds
    s_add_u32 m0, s81, 72704
    s_mov_b32 s5, 57344
    buffer_load_dwordx4 v195, s[36:39], s5 offen lds
    s_add_u32 m0, s81, 73728
    s_mov_b32 s5, 65536
    buffer_load_dwordx4 v195, s[36:39], s5 offen lds
    s_add_u32 m0, s81, 74752
    s_mov_b32 s5, 73728
    buffer_load_dwordx4 v195, s[36:39], s5 offen lds
    s_waitcnt lgkmcnt(0)
    s_barrier
    s_add_u32 m0, s81, 75776
    s_mov_b32 s5, 81920
    buffer_load_dwordx4 v195, s[36:39], s5 offen lds
    s_add_u32 m0, s81, 76800
    s_mov_b32 s5, 90112
    buffer_load_dwordx4 v195, s[36:39], s5 offen lds
    s_add_u32 m0, s81, 77824
    s_mov_b32 s5, 98304
    buffer_load_dwordx4 v195, s[36:39], s5 offen lds
    s_add_u32 m0, s81, 78848
    s_mov_b32 s5, 106496
    buffer_load_dwordx4 v195, s[36:39], s5 offen lds
    s_add_u32 m0, s81, 79872
    s_mov_b32 s5, 114688
    buffer_load_dwordx4 v195, s[36:39], s5 offen lds
    s_add_u32 m0, s81, 80896
    s_mov_b32 s5, 122880
    buffer_load_dwordx4 v195, s[36:39], s5 offen lds
    s_add_u32 s5, s82, 16384
    buffer_load_dwordx4 v[196:199], v4, s[24:27], s5 offen offset:0
    buffer_load_dwordx4 v[200:203], v4, s[24:27], s5 offen offset:1024
    buffer_load_dwordx4 v[204:207], v4, s[24:27], s5 offen offset:2048
    buffer_load_dwordx4 v[208:211], v4, s[24:27], s5 offen offset:3072
    s_add_u32 s5, s82, 20480
    buffer_load_dwordx4 v[212:215], v4, s[24:27], s5 offen offset:0
    buffer_load_dwordx4 v[216:219], v4, s[24:27], s5 offen offset:1024
    buffer_load_dwordx4 v[220:223], v4, s[24:27], s5 offen offset:2048
    buffer_load_dwordx4 v[224:227], v4, s[24:27], s5 offen offset:3072
    s_waitcnt vmcnt(8)
    s_waitcnt lgkmcnt(0)
    s_barrier
    s_setprio 0
    s_add_u32 s5, s82, 24576
    buffer_load_dwordx4 v[228:231], v4, s[24:27], s5 offen offset:0
    buffer_load_dwordx4 v[232:235], v4, s[24:27], s5 offen offset:1024
    buffer_load_dwordx4 v[236:239], v4, s[24:27], s5 offen offset:2048
    buffer_load_dwordx4 v[84:87], v4, s[24:27], s5 offen offset:3072
    s_add_u32 s5, s82, 28672
    buffer_load_dwordx4 v[88:91], v4, s[24:27], s5 offen offset:0
    buffer_load_dwordx4 v[92:95], v4, s[24:27], s5 offen offset:1024
    buffer_load_dwordx4 v[96:99], v4, s[24:27], s5 offen offset:2048
    buffer_load_dwordx4 v[100:103], v4, s[24:27], s5 offen offset:3072
    s_and_b32 s4, s3, 1
    s_lshr_b32 s5, s3, 2
    s_lshl_b32 s5, s5, 1
    s_add_u32 s5, s5, s4
    s_lshl_b32 s4, s68, 16
    s_bfe_u32 s7, s3, 0x10001
    s_lshl_b32 s6, s7, 15
    s_add_u32 s4, s4, s6
    s_lshl_b32 s6, s5, 13
    s_add_u32 s4, s4, s6
    s_add_u32 s84, s4, 3670016
    s_lshl_b32 s4, s5, 14
    s_add_u32 s4, s4, 65536
    v_add_u32 v7, s4, v13
    ds_read_b64_tr_b16 v[132:133], v192 offset:0
    ds_read_b64_tr_b16 v[134:135], v192 offset:1024
    ds_read_b64_tr_b16 v[136:137], v192 offset:2048
    ds_read_b64_tr_b16 v[138:139], v192 offset:3072
    ds_read_b64_tr_b16 v[140:141], v192 offset:4096
    ds_read_b64_tr_b16 v[142:143], v192 offset:5120
    ds_read_b64_tr_b16 v[144:145], v192 offset:6144
    ds_read_b64_tr_b16 v[146:147], v192 offset:7168
    s_waitcnt lgkmcnt(6)
    v_mfma_f32_32x32x16_bf16 v[112:127], v[132:135], v[20:23], 0
    ds_read_b64_tr_b16 v[132:133], v192 offset:8192
    ds_read_b64_tr_b16 v[134:135], v192 offset:9216
    s_waitcnt lgkmcnt(6)
    v_mfma_f32_32x32x16_bf16 v[112:127], v[136:139], v[24:27], v[112:127]
    ds_read_b64_tr_b16 v[136:137], v192 offset:10240
    ds_read_b64_tr_b16 v[138:139], v192 offset:11264
    s_waitcnt lgkmcnt(6)
    v_mfma_f32_32x32x16_bf16 v[112:127], v[140:143], v[28:31], v[112:127]
    ds_read_b64_tr_b16 v[140:141], v192 offset:12288
    ds_read_b64_tr_b16 v[142:143], v192 offset:13312
    s_waitcnt lgkmcnt(6)
    v_mfma_f32_32x32x16_bf16 v[112:127], v[144:147], v[32:35], v[112:127]
    ds_read_b64_tr_b16 v[144:145], v192 offset:14336
    ds_read_b64_tr_b16 v[146:147], v192 offset:15360
    s_waitcnt lgkmcnt(6)
    v_mfma_f32_32x32x16_bf16 v[112:127], v[132:135], v[36:39], v[112:127]
    ds_read_b64_tr_b16 v[132:133], v192 offset:16384
    ds_read_b64_tr_b16 v[134:135], v192 offset:17408
    s_waitcnt lgkmcnt(6)
    v_mfma_f32_32x32x16_bf16 v[112:127], v[136:139], v[40:43], v[112:127]
    ds_read_b64_tr_b16 v[136:137], v192 offset:18432
    ds_read_b64_tr_b16 v[138:139], v192 offset:19456
    s_waitcnt lgkmcnt(6)
    v_mfma_f32_32x32x16_bf16 v[112:127], v[140:143], v[44:47], v[112:127]
    ds_read_b64_tr_b16 v[140:141], v192 offset:20480
    ds_read_b64_tr_b16 v[142:143], v192 offset:21504
    s_waitcnt lgkmcnt(6)
    v_mfma_f32_32x32x16_bf16 v[112:127], v[144:147], v[48:51], v[112:127]
    ds_read_b64_tr_b16 v[144:145], v192 offset:22528
    ds_read_b64_tr_b16 v[146:147], v192 offset:23552
    s_waitcnt lgkmcnt(6)
    v_mfma_f32_32x32x16_bf16 v[112:127], v[132:135], v[52:55], v[112:127]
    ds_read_b64_tr_b16 v[132:133], v192 offset:24576
    ds_read_b64_tr_b16 v[134:135], v192 offset:25600
    s_waitcnt lgkmcnt(6)
    v_mfma_f32_32x32x16_bf16 v[112:127], v[136:139], v[56:59], v[112:127]
    ds_read_b64_tr_b16 v[136:137], v192 offset:26624
    ds_read_b64_tr_b16 v[138:139], v192 offset:27648
    s_waitcnt lgkmcnt(6)
    v_mfma_f32_32x32x16_bf16 v[112:127], v[140:143], v[60:63], v[112:127]
    ds_read_b64_tr_b16 v[140:141], v192 offset:28672
    ds_read_b64_tr_b16 v[142:143], v192 offset:29696
    s_waitcnt lgkmcnt(6)
    v_mfma_f32_32x32x16_bf16 v[112:127], v[144:147], v[64:67], v[112:127]
    ds_read_b64_tr_b16 v[144:145], v192 offset:30720
    ds_read_b64_tr_b16 v[146:147], v192 offset:31744
    s_waitcnt lgkmcnt(6)
    v_mfma_f32_32x32x16_bf16 v[112:127], v[132:135], v[68:71], v[112:127]
    ds_read_b64_tr_b16 v[132:133], v192 offset:32768
    ds_read_b64_tr_b16 v[134:135], v192 offset:33792
    s_waitcnt lgkmcnt(6)
    v_mfma_f32_32x32x16_bf16 v[112:127], v[136:139], v[72:75], v[112:127]
    ds_read_b64_tr_b16 v[136:137], v192 offset:34816
    ds_read_b64_tr_b16 v[138:139], v192 offset:35840
    s_waitcnt lgkmcnt(6)
    v_mfma_f32_32x32x16_bf16 v[112:127], v[140:143], v[76:79], v[112:127]
    ds_read_b64_tr_b16 v[140:141], v192 offset:36864
    ds_read_b64_tr_b16 v[142:143], v192 offset:37888
    s_waitcnt lgkmcnt(6)
    v_mfma_f32_32x32x16_bf16 v[112:127], v[144:147], v[80:83], v[112:127]
    ds_read_b64_tr_b16 v[144:145], v192 offset:38912
    ds_read_b64_tr_b16 v[146:147], v192 offset:39936
    s_waitcnt vmcnt(15)
    s_waitcnt lgkmcnt(6)
    v_mfma_f32_32x32x16_bf16 v[112:127], v[132:135], v[196:199], v[112:127]
    s_waitcnt vmcnt(14)
    s_waitcnt lgkmcnt(4)
    v_mfma_f32_32x32x16_bf16 v[112:127], v[136:139], v[200:203], v[112:127]
    s_waitcnt vmcnt(13)
    s_waitcnt lgkmcnt(2)
    v_mfma_f32_32x32x16_bf16 v[112:127], v[140:143], v[204:207], v[112:127]
    s_waitcnt vmcnt(12)
    s_waitcnt lgkmcnt(0)
    v_mfma_f32_32x32x16_bf16 v[112:127], v[144:147], v[208:211], v[112:127]
    s_barrier
    ds_read_b64_tr_b16 v[132:133], v192 offset:40960
    ds_read_b64_tr_b16 v[134:135], v192 offset:41984
    ds_read_b64_tr_b16 v[136:137], v192 offset:43008
    ds_read_b64_tr_b16 v[138:139], v192 offset:44032
    ds_read_b64_tr_b16 v[140:141], v192 offset:45056
    ds_read_b64_tr_b16 v[142:143], v192 offset:46080
    ds_read_b64_tr_b16 v[144:145], v192 offset:47104
    ds_read_b64_tr_b16 v[146:147], v192 offset:48128
    s_waitcnt vmcnt(11)
    s_waitcnt lgkmcnt(6)
    v_mfma_f32_32x32x16_bf16 v[112:127], v[132:135], v[212:215], v[112:127]
    ds_read_b64_tr_b16 v[132:133], v192 offset:49152
    ds_read_b64_tr_b16 v[134:135], v192 offset:50176
    s_waitcnt vmcnt(10)
    s_waitcnt lgkmcnt(6)
    v_mfma_f32_32x32x16_bf16 v[112:127], v[136:139], v[216:219], v[112:127]
    ds_read_b64_tr_b16 v[136:137], v192 offset:51200
    ds_read_b64_tr_b16 v[138:139], v192 offset:52224
    s_waitcnt vmcnt(9)
    s_waitcnt lgkmcnt(6)
    v_mfma_f32_32x32x16_bf16 v[112:127], v[140:143], v[220:223], v[112:127]
    ds_read_b64_tr_b16 v[140:141], v192 offset:53248
    ds_read_b64_tr_b16 v[142:143], v192 offset:54272
    s_waitcnt vmcnt(8)
    s_waitcnt lgkmcnt(6)
    v_mfma_f32_32x32x16_bf16 v[112:127], v[144:147], v[224:227], v[112:127]
    ds_read_b64_tr_b16 v[144:145], v192 offset:55296
    ds_read_b64_tr_b16 v[146:147], v192 offset:56320
    s_waitcnt vmcnt(7)
    s_waitcnt lgkmcnt(6)
    v_mfma_f32_32x32x16_bf16 v[112:127], v[132:135], v[228:231], v[112:127]
    ds_read_b64_tr_b16 v[132:133], v192 offset:57344
    ds_read_b64_tr_b16 v[134:135], v192 offset:58368
    s_waitcnt vmcnt(6)
    s_waitcnt lgkmcnt(6)
    v_mfma_f32_32x32x16_bf16 v[112:127], v[136:139], v[232:235], v[112:127]
    ds_read_b64_tr_b16 v[136:137], v192 offset:59392
    ds_read_b64_tr_b16 v[138:139], v192 offset:60416
    s_waitcnt vmcnt(5)
    s_waitcnt lgkmcnt(6)
    v_mfma_f32_32x32x16_bf16 v[112:127], v[140:143], v[236:239], v[112:127]
    ds_read_b64_tr_b16 v[140:141], v192 offset:61440
    ds_read_b64_tr_b16 v[142:143], v192 offset:62464
    s_waitcnt vmcnt(4)
    s_waitcnt lgkmcnt(6)
    v_mfma_f32_32x32x16_bf16 v[112:127], v[144:147], v[84:87], v[112:127]
    ds_read_b64_tr_b16 v[144:145], v192 offset:63488
    ds_read_b64_tr_b16 v[146:147], v192 offset:64512
    s_waitcnt vmcnt(3)
    s_waitcnt lgkmcnt(6)
    v_mfma_f32_32x32x16_bf16 v[112:127], v[132:135], v[88:91], v[112:127]
    s_waitcnt vmcnt(2)
    s_waitcnt lgkmcnt(4)
    v_mfma_f32_32x32x16_bf16 v[112:127], v[136:139], v[92:95], v[112:127]
    s_waitcnt vmcnt(1)
    s_waitcnt lgkmcnt(2)
    v_mfma_f32_32x32x16_bf16 v[112:127], v[140:143], v[96:99], v[112:127]
    s_waitcnt vmcnt(0)
    s_waitcnt lgkmcnt(0)
    v_mfma_f32_32x32x16_bf16 v[112:127], v[144:147], v[100:103], v[112:127]
    v_xor_b32 v8, 64, v7
    ds_read_b64_tr_b16 v[228:229], v7 offset:0
    ds_read_b64_tr_b16 v[230:231], v7 offset:1024
    ds_read_b64_tr_b16 v[232:233], v7 offset:2048
    ds_read_b64_tr_b16 v[234:235], v7 offset:3072
    ds_read_b64_tr_b16 v[236:237], v7 offset:4096
    ds_read_b64_tr_b16 v[238:239], v7 offset:5120
    ds_read_b64_tr_b16 v[84:85], v7 offset:6144
    ds_read_b64_tr_b16 v[86:87], v7 offset:7168
    ds_read_b64_tr_b16 v[88:89], v7 offset:8192
    ds_read_b64_tr_b16 v[90:91], v7 offset:9216
    ds_read_b64_tr_b16 v[92:93], v7 offset:10240
    ds_read_b64_tr_b16 v[94:95], v7 offset:11264
    ds_read_b64_tr_b16 v[96:97], v7 offset:12288
    ds_read_b64_tr_b16 v[98:99], v7 offset:13312
    ds_read_b64_tr_b16 v[100:101], v7 offset:14336
    ds_read_b64_tr_b16 v[102:103], v7 offset:15360
    ds_read_b64_tr_b16 v[104:105], v8 offset:0
    ds_read_b64_tr_b16 v[106:107], v8 offset:1024
    ds_read_b64_tr_b16 v[148:149], v8 offset:2048
    ds_read_b64_tr_b16 v[150:151], v8 offset:3072
    ds_read_b64_tr_b16 v[152:153], v8 offset:4096
    ds_read_b64_tr_b16 v[154:155], v8 offset:5120
    ds_read_b64_tr_b16 v[156:157], v8 offset:6144
    ds_read_b64_tr_b16 v[158:159], v8 offset:7168
    ds_read_b64_tr_b16 v[160:161], v8 offset:8192
    ds_read_b64_tr_b16 v[162:163], v8 offset:9216
    ds_read_b64_tr_b16 v[168:169], v8 offset:10240
    ds_read_b64_tr_b16 v[170:171], v8 offset:11264
    ds_read_b64_tr_b16 v[172:173], v8 offset:12288
    ds_read_b64_tr_b16 v[174:175], v8 offset:13312
    ds_read_b64_tr_b16 v[176:177], v8 offset:14336
    ds_read_b64_tr_b16 v[178:179], v8 offset:15360
    s_barrier
    s_add_u32 s5, s84, 0
    buffer_load_dwordx4 v[20:23], v4, s[24:27], s5 offen offset:0
    buffer_load_dwordx4 v[24:27], v4, s[24:27], s5 offen offset:1024
    buffer_load_dwordx4 v[28:31], v4, s[24:27], s5 offen offset:2048
    buffer_load_dwordx4 v[32:35], v4, s[24:27], s5 offen offset:3072
    s_add_u32 s5, s84, 4096
    buffer_load_dwordx4 v[36:39], v4, s[24:27], s5 offen offset:0
    buffer_load_dwordx4 v[40:43], v4, s[24:27], s5 offen offset:1024
    buffer_load_dwordx4 v[44:47], v4, s[24:27], s5 offen offset:2048
    buffer_load_dwordx4 v[48:51], v4, s[24:27], s5 offen offset:3072
    s_bfe_u32 s4, s3, 0x10001
    s_mul_i32 s4, s4, 24576
    s_add_u32 s4, s4, 0
    v_add_u32 v8, s4, v4
    s_waitcnt lgkmcnt(0)
    s_waitcnt vmcnt(7)
    v_mfma_f32_32x32x16_bf16 v[196:211], v[228:231], v[20:23], 0
    v_mfma_f32_32x32x16_bf16 v[212:227], v[104:107], v[20:23], 0
    s_waitcnt vmcnt(6)
    v_mfma_f32_32x32x16_bf16 v[196:211], v[232:235], v[24:27], v[196:211]
    v_mfma_f32_32x32x16_bf16 v[212:227], v[148:151], v[24:27], v[212:227]
    s_waitcnt vmcnt(5)
    v_mfma_f32_32x32x16_bf16 v[196:211], v[236:239], v[28:31], v[196:211]
    v_mfma_f32_32x32x16_bf16 v[212:227], v[152:155], v[28:31], v[212:227]
    s_waitcnt vmcnt(4)
    v_mfma_f32_32x32x16_bf16 v[196:211], v[84:87], v[32:35], v[196:211]
    v_mfma_f32_32x32x16_bf16 v[212:227], v[156:159], v[32:35], v[212:227]
    s_waitcnt vmcnt(3)
    v_mfma_f32_32x32x16_bf16 v[196:211], v[88:91], v[36:39], v[196:211]
    v_mfma_f32_32x32x16_bf16 v[212:227], v[160:163], v[36:39], v[212:227]
    s_waitcnt vmcnt(2)
    v_mfma_f32_32x32x16_bf16 v[196:211], v[92:95], v[40:43], v[196:211]
    v_mfma_f32_32x32x16_bf16 v[212:227], v[168:171], v[40:43], v[212:227]
    s_waitcnt vmcnt(1)
    v_mfma_f32_32x32x16_bf16 v[196:211], v[96:99], v[44:47], v[196:211]
    v_mfma_f32_32x32x16_bf16 v[212:227], v[172:175], v[44:47], v[212:227]
    s_waitcnt vmcnt(0)
    v_mfma_f32_32x32x16_bf16 v[196:211], v[100:103], v[48:51], v[196:211]
    v_mfma_f32_32x32x16_bf16 v[212:227], v[176:179], v[48:51], v[212:227]
    v_sub_f32 v6, 1.0, v108
    v_mul_f32 v112, v112, v108
    v_mul_f32 v113, v113, v108
    v_mul_f32 v114, v114, v108
    v_mul_f32 v115, v115, v108
    v_mul_f32 v116, v116, v108
    v_mul_f32 v117, v117, v108
    v_mul_f32 v118, v118, v108
    v_mul_f32 v119, v119, v108
    v_mul_f32 v120, v120, v108
    v_mul_f32 v121, v121, v108
    v_mul_f32 v122, v122, v108
    v_mul_f32 v123, v123, v108
    v_mul_f32 v124, v124, v108
    v_mul_f32 v125, v125, v108
    v_mul_f32 v126, v126, v108
    v_mul_f32 v127, v127, v108
    s_bitcmp1_b32 s3, 0
    s_cbranch_scc1 gated_mix__sliding_local_dilated__grouped_kv_mqa__prompt_kernel_fq1
    ds_write_b128 v8, v[212:215] offset:20480
    ds_write_b128 v8, v[216:219] offset:21504
    ds_write_b128 v8, v[220:223] offset:22528
    ds_write_b128 v8, v[224:227] offset:23552
    v_fmac_f32 v112, v196, v6
    v_fmac_f32 v113, v197, v6
    v_fmac_f32 v114, v198, v6
    v_fmac_f32 v115, v199, v6
    v_fmac_f32 v116, v200, v6
    v_fmac_f32 v117, v201, v6
    v_fmac_f32 v118, v202, v6
    v_fmac_f32 v119, v203, v6
    v_fmac_f32 v120, v204, v6
    v_fmac_f32 v121, v205, v6
    v_fmac_f32 v122, v206, v6
    v_fmac_f32 v123, v207, v6
    v_fmac_f32 v124, v208, v6
    v_fmac_f32 v125, v209, v6
    v_fmac_f32 v126, v210, v6
    v_fmac_f32 v127, v211, v6
    s_branch gated_mix__sliding_local_dilated__grouped_kv_mqa__prompt_kernel_fq2
gated_mix__sliding_local_dilated__grouped_kv_mqa__prompt_kernel_fq1:
    ds_write_b128 v8, v[196:199] offset:8192
    ds_write_b128 v8, v[200:203] offset:9216
    ds_write_b128 v8, v[204:207] offset:10240
    ds_write_b128 v8, v[208:211] offset:11264
    v_fmac_f32 v112, v212, v6
    v_fmac_f32 v113, v213, v6
    v_fmac_f32 v114, v214, v6
    v_fmac_f32 v115, v215, v6
    v_fmac_f32 v116, v216, v6
    v_fmac_f32 v117, v217, v6
    v_fmac_f32 v118, v218, v6
    v_fmac_f32 v119, v219, v6
    v_fmac_f32 v120, v220, v6
    v_fmac_f32 v121, v221, v6
    v_fmac_f32 v122, v222, v6
    v_fmac_f32 v123, v223, v6
    v_fmac_f32 v124, v224, v6
    v_fmac_f32 v125, v225, v6
    v_fmac_f32 v126, v226, v6
    v_fmac_f32 v127, v227, v6
    v_add_u32 v8, 12288, v8
gated_mix__sliding_local_dilated__grouped_kv_mqa__prompt_kernel_fq2:
    v_lshlrev_b32 v5, 10, v3
    v_lshl_add_u32 v5, v2, 4, v5
    s_lshl_b32 s4, s68, 16
    s_bfe_u32 s5, s3, 0x10001
    s_lshl_b32 s5, s5, 15
    s_add_u32 s4, s4, s5
    s_lshl_b32 s5, s69, 7
    s_add_u32 s4, s4, s5
    s_and_b32 s5, s3, 1
    s_lshl_b32 s5, s5, 6
    s_add_u32 s4, s4, s5
    s_waitcnt lgkmcnt(0)
    s_barrier
    ds_read_b128 v[20:23], v8 offset:0
    ds_read_b128 v[24:27], v8 offset:1024
    ds_read_b128 v[28:31], v8 offset:2048
    ds_read_b128 v[32:35], v8 offset:3072
    ds_read_b128 v[36:39], v8 offset:4096
    ds_read_b128 v[40:43], v8 offset:5120
    ds_read_b128 v[44:47], v8 offset:6144
    ds_read_b128 v[48:51], v8 offset:7168
    ds_read_b128 v[52:55], v8 offset:8192
    ds_read_b128 v[56:59], v8 offset:9216
    ds_read_b128 v[60:63], v8 offset:10240
    ds_read_b128 v[64:67], v8 offset:11264
    s_waitcnt lgkmcnt(11)
    v_fmac_f32 v112, v20, v6
    v_fmac_f32 v113, v21, v6
    v_fmac_f32 v114, v22, v6
    v_fmac_f32 v115, v23, v6
    s_waitcnt lgkmcnt(10)
    v_fmac_f32 v116, v24, v6
    v_fmac_f32 v117, v25, v6
    v_fmac_f32 v118, v26, v6
    v_fmac_f32 v119, v27, v6
    s_waitcnt lgkmcnt(9)
    v_fmac_f32 v120, v28, v6
    v_fmac_f32 v121, v29, v6
    v_fmac_f32 v122, v30, v6
    v_fmac_f32 v123, v31, v6
    s_waitcnt lgkmcnt(8)
    v_fmac_f32 v124, v32, v6
    v_fmac_f32 v125, v33, v6
    v_fmac_f32 v126, v34, v6
    v_fmac_f32 v127, v35, v6
    s_waitcnt lgkmcnt(7)
    v_fmac_f32 v112, v36, v6
    v_fmac_f32 v113, v37, v6
    v_fmac_f32 v114, v38, v6
    v_fmac_f32 v115, v39, v6
    s_waitcnt lgkmcnt(6)
    v_fmac_f32 v116, v40, v6
    v_fmac_f32 v117, v41, v6
    v_fmac_f32 v118, v42, v6
    v_fmac_f32 v119, v43, v6
    s_waitcnt lgkmcnt(5)
    v_fmac_f32 v120, v44, v6
    v_fmac_f32 v121, v45, v6
    v_fmac_f32 v122, v46, v6
    v_fmac_f32 v123, v47, v6
    s_waitcnt lgkmcnt(4)
    v_fmac_f32 v124, v48, v6
    v_fmac_f32 v125, v49, v6
    v_fmac_f32 v126, v50, v6
    v_fmac_f32 v127, v51, v6
    s_waitcnt lgkmcnt(3)
    v_fmac_f32 v112, v52, v6
    v_fmac_f32 v113, v53, v6
    v_fmac_f32 v114, v54, v6
    v_fmac_f32 v115, v55, v6
    s_waitcnt lgkmcnt(2)
    v_fmac_f32 v116, v56, v6
    v_fmac_f32 v117, v57, v6
    v_fmac_f32 v118, v58, v6
    v_fmac_f32 v119, v59, v6
    s_waitcnt lgkmcnt(1)
    v_fmac_f32 v120, v60, v6
    v_fmac_f32 v121, v61, v6
    v_fmac_f32 v122, v62, v6
    v_fmac_f32 v123, v63, v6
    s_waitcnt lgkmcnt(0)
    v_fmac_f32 v124, v64, v6
    v_fmac_f32 v125, v65, v6
    v_fmac_f32 v126, v66, v6
    v_fmac_f32 v127, v67, v6
    v_cvt_pk_bf16_f32 v20, v112, v113
    v_cvt_pk_bf16_f32 v21, v114, v115
    v_cvt_pk_bf16_f32 v22, v116, v117
    v_cvt_pk_bf16_f32 v23, v118, v119
    v_cvt_pk_bf16_f32 v24, v120, v121
    v_cvt_pk_bf16_f32 v25, v122, v123
    v_cvt_pk_bf16_f32 v26, v124, v125
    v_cvt_pk_bf16_f32 v27, v126, v127
    s_nop 1
    v_permlane32_swap_b32 v20, v22
    v_permlane32_swap_b32 v21, v23
    v_permlane32_swap_b32 v24, v26
    v_permlane32_swap_b32 v25, v27
    s_nop 1
    buffer_store_dwordx4 v[20:23], v5, s[40:43], s4 offen offset:0
    buffer_store_dwordx4 v[24:27], v5, s[40:43], s4 offen offset:32
gated_mix__sliding_local_dilated__grouped_kv_mqa__prompt_kernel_end:
    s_endpgm
.section .rodata,"a"
.p2align 6
.amdhsa_kernel gated_mix__sliding_local_dilated__grouped_kv_mqa__prompt_kernel
  .amdhsa_next_free_vgpr 240
  .amdhsa_next_free_sgpr 102
  .amdhsa_accum_offset 240
  .amdhsa_group_segment_fixed_size 0
  .amdhsa_kernarg_size 96
  .amdhsa_user_sgpr_count 2
  .amdhsa_user_sgpr_kernarg_segment_ptr 1
  .amdhsa_system_sgpr_workgroup_id_x 1
.end_amdhsa_kernel
```
